```python
import torch

def _softmax(x, axis=-1):
    return torch.softmax(x, dim=axis)
def _gelu(x):
    return torch.nn.functional.gelu(x, approximate="tanh")
def _silu(x):
    return torch.nn.functional.silu(x)
def _sigmoid(x):
    return torch.sigmoid(x)
def _layernorm(x, axis=-1, eps=1e-5):
    m = x.mean(dim=axis, keepdim=True)
    v = x.var(dim=axis, keepdim=True, unbiased=False)
    return (x - m) / torch.sqrt(v + eps)
def _scatter_add(tgt, idx, src, axis=0):
    return tgt.clone().index_add_(axis, idx, src)
def _segment_sum(src, seg, n):
    out = torch.zeros((n,) + src.shape[1:], dtype=src.dtype)
    return out.index_add_(0, seg, src)
def _pad(x, pw):
    flat = tuple(v for pair in reversed(pw) for v in pair)
    return torch.nn.functional.pad(x, flat)

kernel_name = 'recurrent_scan__ssm_conv_s4__mixer_channel_mlp__prompt'

def setup_inputs():

    _w = (lambda a: (lambda t: t.to(torch.bfloat16) if t.is_floating_point() else t)(torch.as_tensor(a)))
    def _A_setup():
        B, L, D, N = 1, 2048, 640, 192
        A_re = -(lambda _x: torch.exp(torch.as_tensor(_x)))((lambda *s: torch.randn(*s, dtype=torch.bfloat16) * 3.2)(D, N))
        A_im = torch.pi * (lambda *s: torch.randn(*s, dtype=torch.bfloat16) * 0.05)(D, N)
        B_re = (lambda *s: torch.randn(*s, dtype=torch.bfloat16) * 0.1)(D, N)
        B_im = (lambda *s: torch.randn(*s, dtype=torch.bfloat16) * 0.1)(D, N)
        C_re = (lambda *s: torch.randn(*s, dtype=torch.bfloat16) * 0.1)(D, N)
        C_im = (lambda *s: torch.randn(*s, dtype=torch.bfloat16) * 0.1)(D, N)
        log_dt = (lambda *s: torch.randn(*s, dtype=torch.bfloat16) * 0.05)(D) * 0.5 - 4.0
        Dskip = (lambda *s: torch.randn(*s, dtype=torch.bfloat16) * 0.05)(D)
        return {
            "u": _w((lambda *s: torch.randn(*s, dtype=torch.bfloat16) * 0.05)(B, L, D)),
            "A_re": _w(A_re),
            "A_im": _w(A_im),
            "B_re": _w(B_re),
            "B_im": _w(B_im),
            "C_re": _w(C_re),
            "C_im": _w(C_im),
            "log_dt": _w(log_dt),
            "Dskip": _w(Dskip),
        }
    _A_in = _A_setup()

    def _B_setup():
        B, S, D, F = 1, 2048, 640, 1536
        return {
            "x": _w((lambda *s: torch.randn(*s, dtype=torch.bfloat16) * 0.05)(B, S, D)),
            "w1": _w((lambda *s: torch.randn(*s, dtype=torch.bfloat16) * 3.2)(D, F) * (D ** -0.5)),
            "b1": _w((lambda *s: torch.randn(*s, dtype=torch.bfloat16) * 1.6)(F)),
            "w2": _w((lambda *s: torch.randn(*s, dtype=torch.bfloat16) * 0.05)(F, D) * (F ** -0.5)),
            "b2": _w((lambda *s: torch.randn(*s, dtype=torch.bfloat16) * 0.1)(D)),
        }
    _B_in = _B_setup()

    return {
        "A_u": _A_in["u"],
        "A_A_re": _A_in["A_re"],
        "A_A_im": _A_in["A_im"],
        "A_B_re": _A_in["B_re"],
        "A_B_im": _A_in["B_im"],
        "A_C_re": _A_in["C_re"],
        "A_C_im": _A_in["C_im"],
        "A_log_dt": _A_in["log_dt"],
        "A_Dskip": _A_in["Dskip"],
        "B_x": _B_in["x"],
        "B_w1": _B_in["w1"],
        "B_b1": _B_in["b1"],
        "B_w2": _B_in["w2"],
        "B_b2": _B_in["b2"],
    }

def reference(A_u, A_A_re, A_A_im, A_B_re, A_B_im, A_C_re, A_C_im, A_log_dt, A_Dskip, B_x, B_w1, B_b1, B_w2, B_b2):
    def _A_ref(u, A_re, A_im, B_re, B_im, C_re, C_im, log_dt, Dskip):
        Bsz, L, D = u.shape
        dt = torch.exp(log_dt)[:, None]
        A = A_re + 1j * A_im
        Bc = B_re + 1j * B_im
        Cc = C_re + 1j * C_im
        logdA = dt * A
        dB = dt * Bc
        l = (lambda x, dt: x.to(dt))(torch.arange(L), A_re.dtype)
        P = torch.exp(logdA[:, :, None] * l[None, None, :])
        K = torch.einsum("dn,dnl,dn->dl", Cc, P, dB).real
        L2 = 2 * L
        Kp = _pad(K, ((0, 0), (0, L)))
        up = (lambda x, *d: x.permute(*d))(u, 0, 2, 1)
        up = _pad(up, ((0, 0), (0, 0), (0, L)))
        Kf = (lambda x, axes=(-2,-1): torch.fft.rfft2(x.float(), dim=axes))(Kp[:, None, :], axes=(-2, -1))
        Uf = (lambda x, axes=(-2,-1): torch.fft.rfft2(x.float(), dim=axes))(up[:, :, None, :], axes=(-2, -1))
        Yf = Uf * Kf[None, :, :, :]
        y = (lambda x, s, axes=(-2,-1): torch.fft.irfft2(x, s=s, dim=axes).to(torch.bfloat16))(Yf, (1, L2), axes=(-2, -1))[:, :, 0, :L]
        y = (lambda x, *d: x.permute(*d))(y, 0, 2, 1) + u * Dskip[None, None, :]
        return y

    def _B_ref(x, w1, b1, w2, b2):
        y = _layernorm(x, axis=-1)
        h = _gelu(torch.einsum("bsd,df->bsf", y, w1) + b1)
        return torch.einsum("bsf,fd->bsd", h, w2) + b2

    x = A_u
    xn = _layernorm(x, axis=-1)
    s = _A_ref(xn, A_A_re, A_A_im, A_B_re, A_B_im, A_C_re, A_C_im, A_log_dt, A_Dskip)
    g = _silu(_B_ref(xn, B_w1, B_b1, B_w2, B_b2))
    return x + s * g
```

```asm
; @launch grid=(256,1,1) block=(512,1,1) lds=163840
.amdgcn_target "amdgcn-amd-amdhsa--gfx950"
.text
.globl recurrent_scan__ssm_conv_s4__mixer_channel_mlp__prompt_kernel
.p2align 8
.type recurrent_scan__ssm_conv_s4__mixer_channel_mlp__prompt_kernel,@function
recurrent_scan__ssm_conv_s4__mixer_channel_mlp__prompt_kernel:
    s_load_dwordx16 s[4:19], s[0:1], 0
    s_load_dwordx16 s[20:35], s[0:1], 64
    s_load_dwordx2 s[36:37], s[0:1], 128
    s_cmp_ge_u32 s2, 256
    s_cbranch_scc1 .Lend0
    s_getpc_b64 s[38:39]
    v_lshrrev_b32 v1, 6, v0
    s_lshr_b32 s61, s2, 3
    v_readfirstlane_b32 s66, v1
    v_lshrrev_b32 v1, 5, v0
    v_lshl_add_u32 v1, s61, 4, v1
    v_lshlrev_b32 v1, 7, v1
    v_min_u32 v1, .Lcode_end-recurrent_scan__ssm_conv_s4__mixer_channel_mlp__prompt_kernel-64, v1
    global_load_dword v255, v1, s[38:39]
    v_lshlrev_b32 v1, 2, v0
    v_mov_b32 v2, 0
    ds_write_b32 v1, v2
    v_and_b32 v0, 63, v0
    s_and_b32 s60, s2, 7
    s_and_b32 s72, s2, 6
    s_lshl_b32 s72, s72, 1
    s_and_b32 s73, s61, 3
    s_add_u32 s62, s72, s73
    s_and_b32 s72, s2, 1
    s_lshl_b32 s72, s72, 3
    s_lshr_b32 s73, s61, 2
    s_add_u32 s63, s72, s73
    s_cmp_ge_u32 s66, 4
    s_cbranch_scc1 .Lmlp0
    s_cmp_lg_u32 s66, 0
    s_cbranch_scc1 .Lssm0
    s_setprio 3
    v_lshlrev_b32 v1, 4, v0
    v_lshlrev_b32 v2, 2, v0
    s_lshl_b32 s70, s62, 7
    s_add_u32 s70, s70, s63
    s_mul_i32 s70, s70, 1280
    s_movk_i32 s71, 20480
    s_waitcnt lgkmcnt(0)
    s_mov_b64 s[40:41], s[4:5]
    s_mov_b32 s42, 2621440
    s_mov_b32 s43, 0x20000
    s_mov_b64 s[44:45], s[36:37]
    s_mov_b32 s46, 268435456
    s_mov_b32 s47, 0x20000
    buffer_load_dword v3, off, s[44:47], 0 sc1
    buffer_load_dwordx4 v[8:11], v1, s[40:43], s70 offen
    buffer_load_dword v40, v2, s[40:43], s70 offen offset:1024
    s_add_u32 s70, s70, s71
    buffer_load_dwordx4 v[12:15], v1, s[40:43], s70 offen
    buffer_load_dword v41, v2, s[40:43], s70 offen offset:1024
    s_add_u32 s70, s70, s71
    buffer_load_dwordx4 v[16:19], v1, s[40:43], s70 offen
    buffer_load_dword v42, v2, s[40:43], s70 offen offset:1024
    s_add_u32 s70, s70, s71
    buffer_load_dwordx4 v[20:23], v1, s[40:43], s70 offen
    buffer_load_dword v43, v2, s[40:43], s70 offen offset:1024
    s_add_u32 s70, s70, s71
    buffer_load_dwordx4 v[24:27], v1, s[40:43], s70 offen
    buffer_load_dword v44, v2, s[40:43], s70 offen offset:1024
    s_add_u32 s70, s70, s71
    buffer_load_dwordx4 v[28:31], v1, s[40:43], s70 offen
    buffer_load_dword v45, v2, s[40:43], s70 offen offset:1024
    s_add_u32 s70, s70, s71
    buffer_load_dwordx4 v[32:35], v1, s[40:43], s70 offen
    buffer_load_dword v46, v2, s[40:43], s70 offen offset:1024
    s_add_u32 s70, s70, s71
    buffer_load_dwordx4 v[36:39], v1, s[40:43], s70 offen
    buffer_load_dword v47, v2, s[40:43], s70 offen offset:1024
    s_barrier
    s_branch .Lhelper
.Lend0:
    s_endpgm
.Lssm0:
    s_mul_i32 s72, s61, 86
    s_lshr_b32 s72, s72, 8
    s_mul_i32 s73, s72, 3
    s_sub_u32 s73, s61, s73
    s_mul_i32 s69, s60, 80
    s_sub_u32 s69, s69, s72
    s_mul_i32 s72, s61, 3
    s_add_u32 s69, s69, s72
    s_cmp_eq_u32 s73, 2
    s_cselect_b32 s68, 2, 3
    s_cmp_ge_u32 s61, 30
    s_cselect_b32 s68, 0, s68
    s_sub_u32 s72, s66, 1
    s_add_u32 s73, s69, s72
    s_and_b32 s74, s73, 63
    s_lshr_b32 s75, s73, 6
    s_lshl_b32 s76, s74, 3
    s_lshl_b32 s77, s74, 1
    s_addk_i32 s77, 504
    s_cmp_ge_u32 s75, 8
    s_cselect_b32 s76, s77, s76
    s_add_u32 s76, s76, s75
    s_min_u32 s76, s76, 639
    s_mul_i32 s70, s76, 384
    v_lshl_add_u32 v1, v0, 2, s70
    v_lshl_add_u32 v2, v0, 1, s70
    s_lshl_b32 s70, s76, 1
    s_and_b32 s70, s70, 0xffc
    s_waitcnt lgkmcnt(0)
    global_load_dword v8, v1, s[6:7]
    global_load_ushort v20, v2, s[6:7] offset:256
    global_load_dword v9, v1, s[8:9]
    global_load_ushort v21, v2, s[8:9] offset:256
    global_load_dword v10, v1, s[10:11]
    global_load_ushort v22, v2, s[10:11] offset:256
    global_load_dword v11, v1, s[12:13]
    global_load_ushort v23, v2, s[12:13] offset:256
    global_load_dword v12, v1, s[14:15]
    global_load_ushort v24, v2, s[14:15] offset:256
    global_load_dword v13, v1, s[16:17]
    global_load_ushort v25, v2, s[16:17] offset:256
    s_load_dword s84, s[18:19], s70
    s_load_dword s85, s[20:21], s70
    s_barrier
    s_branch .Lssm
.Lmlp0:
    s_sub_u32 s72, s66, 4
    v_bfe_u32 v18, v0, 3, 2
    v_lshrrev_b32 v19, 5, v0
    v_lshl_add_u32 v18, v19, 8, v18
    v_mul_u32_u24 v18, 1280, v18
    v_and_b32 v20, 7, v0
    v_lshlrev_b32 v19, 2, v19
    v_xor_b32 v19, v19, v20
    v_lshl_add_u32 v1, v19, 4, v18
    v_xor_b32 v21, 16, v1
    v_add_u32 v2, 19456, v21
    v_xor_b32 v21, 32, v1
    v_add_u32 v3, 38912, v21
    v_xor_b32 v21, 48, v1
    v_add_u32 v4, 58368, v21
    s_lshr_b32 s70, s62, 2
    s_lshl_b32 s70, s70, 7
    s_and_b32 s71, s62, 3
    s_lshl_b32 s71, s71, 4
    s_add_u32 s70, s70, s71
    s_add_u32 s70, s70, s72
    s_mul_i32 s75, s70, 5120
    s_add_u32 s70, s62, s63
    s_mov_b32 s85, 0x65832140
    s_mov_b32 s86, 0x75436102
    s_bitcmp1_b32 s70, 0
    s_cselect_b32 s85, 0x69432501, s85
    s_cselect_b32 s86, 0x65472103, s86
    s_bitcmp1_b32 s70, 1
    s_cselect_b32 s0, s86, s85
    s_and_b32 s70, s70, 3
    s_lshl_b32 s70, s70, 3
    s_lshr_b32 s1, 0x98988797, s70
    s_and_b32 s74, s0, 15
    s_mul_i32 s77, s72, 12288
    s_add_u32 s77, s77, 53248
    v_lshrrev_b32 v18, 2, v0
    v_mul_u32_u24 v18, 3072, v18
    v_and_b32_e64 v19, 3, v0
    v_lshl_add_u32 v18, v19, 4, v18
    v_add_u32 v5, 2048, v18
    v_add_u32 v6, 1088, v18
    v_add_u32 v7, 128, v18
    s_mul_i32 s76, s63, 192
    s_mul_i32 s70, s72, 49152
    s_add_u32 s76, s76, s70
    s_mul_i32 s79, s72, 80
    s_add_u32 s79, s79, 64
    v_mov_b32 v23, 0
    s_mul_i32 s78, s72, 3072
    s_add_u32 s78, s78, 102400
    s_waitcnt lgkmcnt(0)
    s_mov_b64 s[40:41], s[4:5]
    s_mov_b32 s42, 2621440
    s_mov_b32 s43, 0x20000
    s_mov_b64 s[44:45], s[36:37]
    s_mov_b32 s46, 268435456
    s_mov_b32 s47, 0x20000
    s_mov_b64 s[52:53], s[28:29]
    s_mov_b32 s54, 1966080
    s_mov_b32 s55, 0x20000
    s_sub_u32 s48, s24, 2048
    s_subb_u32 s49, s25, 0
    s_mov_b32 s50, 1968128
    s_mov_b32 s51, 0x20000
    s_barrier
    s_setprio 1
    s_add_u32 m0, s77, 0
    s_lshl_b32 s87, s74, 7
    s_add_u32 s87, s87, s75
    buffer_load_dwordx4 v1, s[40:43], s87 offen offset:0 lds
    buffer_load_dwordx4 v2, s[40:43], s87 offen offset:1024 lds
    buffer_load_dwordx4 v3, s[40:43], s87 offen offset:2048 lds
    buffer_load_dwordx4 v4, s[40:43], s87 offen offset:3072 lds
    s_add_u32 m0, s78, 0
    s_mul_i32 s87, s74, 196608
    s_add_u32 s87, s87, s76
    buffer_load_dwordx4 v5, s[48:51], s87 offen offset:0 lds
    buffer_load_dwordx4 v6, s[48:51], s87 offen offset:1024 lds
    buffer_load_dwordx4 v7, s[48:51], s87 offen offset:2048 lds
    s_add_u32 m0, s79, 0
    s_mov_b64 exec, 1
    global_load_lds_dword v23, s[38:39]
    s_mov_b64 exec, -1
    s_lshr_b64 s[0:1], s[0:1], 4
    s_and_b32 s74, s0, 15
    s_min_u32 s82, s2, 239
    s_mul_i32 s80, s82, 52429
    s_lshr_b32 s80, s80, 18
    s_mul_i32 s81, s80, 5
    s_sub_u32 s81, s82, s81
    s_mul_i32 s82, s80, 40960
    s_lshl_b32 s83, s81, 8
    s_add_u32 s82, s82, s83
    s_lshr_b32 s83, s72, 1
    s_lshl_b32 s83, s83, 7
    s_add_u32 s82, s82, s83
    s_and_b32 s83, s72, 1
    s_lshl_b32 s83, s83, 2
    s_add_u32 s82, s82, s83
    s_add_u32 s83, s82, 10240
    v_lshrrev_b32 v18, 5, v0
    v_bfe_u32 v19, v0, 4, 1
    v_lshl_add_u32 v18, v18, 2, v19
    v_mul_u32_u24 v18, 5120, v18
    v_and_b32 v19, 15, v0
    v_lshl_add_u32 v18, v19, 3, v18
    v_mov_b32 v30, v18
    s_mov_b64 s[56:57], s[82:83]
    v_and_b32 v9, 3, v0
    v_mul_u32_u24 v31, 80, v9
    v_bfe_u32 v18, v0, 3, 2
    v_and_b32 v19, 4, v0
    v_add_u32 v18, v18, v19
    v_lshl_add_u32 v18, v9, 3, v18
    v_lshrrev_b32 v19, 5, v0
    v_and_b32 v20, 7, v0
    v_xor_b32 v19, v19, v20
    v_lshl_add_u32 v18, v18, 7, s77
    v_lshrrev_b32 v21, 5, v0
    v_lshlrev_b32_e64 v21, 9, v21
    v_bfe_u32 v22, v0, 2, 2
    v_lshl_add_u32 v21, v22, 6, v21
    v_bfe_u32 v22, v0, 4, 1
    v_lshl_add_u32 v21, v22, 5, v21
    v_lshl_add_u32 v21, v9, 3, v21
    s_add_u32 s70, s72, 0
    s_and_b32 s70, s70, 3
    s_lshl_b32 s71, s70, 1
    v_xor_b32 v20, s71, v19
    v_lshl_add_u32 v10, v20, 4, v18
    s_mul_i32 s70, s70, 3072
    s_add_u32 s70, s70, 102400
    v_add_u32 v14, s70, v21
    s_add_u32 s70, s72, 1
    s_and_b32 s70, s70, 3
    s_lshl_b32 s71, s70, 1
    v_xor_b32_e64 v20, s71, v19
    v_lshl_add_u32 v11, v20, 4, v18
    s_mul_i32 s70, s70, 3072
    s_add_u32 s70, s70, 102400
    v_add_u32 v15, s70, v21
    s_add_u32 s70, s72, 2
    s_and_b32 s70, s70, 3
    s_lshl_b32 s71, s70, 1
    v_xor_b32_e64 v20, s71, v19
    v_lshl_add_u32 v12, v20, 4, v18
    s_mul_i32 s70, s70, 3072
    s_add_u32 s70, s70, 102400
    v_add_u32 v16, s70, v21
    s_add_u32 s70, s72, 3
    s_and_b32 s70, s70, 3
    s_lshl_b32 s71, s70, 1
    v_xor_b32_e64 v20, s71, v19
    v_lshl_add_u32 v13, v20, 4, v18
    s_mul_i32 s70, s70, 3072
    s_add_u32 s70, s70, 102400
    v_add_u32 v17, s70, v21
    v_lshlrev_b32 v18, 2, v22
    v_and_b32 v19, 15, v0
    v_xor_b32 v18, v18, v19
    v_mov_b32 v19, 0x3f803f80
    v_cmp_eq_u32 vcc, 0, v18
    s_nop 1
    v_cndmask_b32 v232, 0, v19, vcc
    v_cndmask_b32 v233, 0, v19, vcc
    v_cndmask_b32 v234, 0, v19, vcc
    v_cndmask_b32 v235, 0, v19, vcc
    v_cmp_eq_u32 vcc, 8, v18
    s_nop 1
    v_cndmask_b32 v236, 0, v19, vcc
    v_cndmask_b32 v237, 0, v19, vcc
    v_cndmask_b32 v238, 0, v19, vcc
    v_cndmask_b32 v239, 0, v19, vcc
    v_lshlrev_b32 v28, 4, v0
    s_lshr_b32 s70, s72, 1
    s_lshl_b32 s82, s81, 1
    s_add_u32 s82, s82, s70
    s_mul_i32 s82, s82, 245760
    s_and_b32 s70, s72, 1
    s_lshl_b32 s70, s70, 11
    s_add_u32 s82, s82, s70
    s_mul_i32 s83, s72, 491520
    s_add_u32 s83, s83, 4096
    s_movk_i32 s70, 1024
    s_cmp_eq_u32 s81, 4
    s_cselect_b32 s82, s83, s82
    s_cselect_b32 s83, 245760, s70
    s_mul_i32 s70, s80, 5120
    s_add_u32 s82, s82, s70
    s_add_u32 s82, s82, 4194304
    s_add_u32 s83, s83, s82
    s_lshl_b32 s70, s2, 2
    s_add_u32 s70, s70, s72
    s_lshl_b32 s70, s70, 12
    s_add_u32 s70, s70, -3670016
    s_add_u32 s71, s70, 1024
    s_cmp_ge_u32 s2, 240
    s_cselect_b32 s58, s70, s82
    s_cselect_b32 s59, s71, s83
    s_mul_i32 s82, s80, 86
    s_lshr_b32 s82, s82, 8
    s_mul_i32 s83, s82, 3
    s_sub_u32 s80, s80, s83
    s_lshr_b32 s83, s82, 2
    s_mul_i32 s83, s83, 3
    s_add_u32 s80, s80, s83
    s_lshl_b32 s80, s80, 2
    s_and_b32 s82, s82, 3
    s_mul_i32 s82, s82, 1280
    s_lshl_b32 s81, s81, 8
    s_add_u32 s81, s81, s82
    s_lshl_b32 s82, s72, 6
    s_add_u32 s81, s81, s82
    s_add_u32 s81, s81, s80
    s_add_u32 s3, s81, 4096
    s_add_u32 s70, s59, 1024
    s_cmp_ge_u32 s2, 240
    s_cselect_b32 s3, s70, s3
    v_mov_b32 v20, 448
    v_and_b32 v211, 31, v0
    s_mul_i32 s70, s63, 192
    v_lshl_add_u32 v213, v211, 1, s70
    buffer_load_dword v220, v30, s[52:55], s56 offen offset:0
    buffer_load_dword v221, v30, s[52:55], s56 offen offset:1280
    buffer_load_dword v222, v30, s[52:55], s56 offen offset:2560
    buffer_load_dword v223, v30, s[52:55], s56 offen offset:3840
    buffer_load_dword v224, v30, s[52:55], s57 offen offset:0
    buffer_load_dword v225, v30, s[52:55], s57 offen offset:1280
    buffer_load_dword v226, v30, s[52:55], s57 offen offset:2560
    buffer_load_dword v227, v30, s[52:55], s57 offen offset:3840
    global_load_ushort v216, v213, s[26:27] offset:0
    global_load_ushort v217, v213, s[26:27] offset:64
    global_load_ushort v218, v213, s[26:27] offset:128
    s_add_u32 m0, s77, 4096
    s_lshl_b32 s87, s74, 7
    s_add_u32 s87, s87, s75
    buffer_load_dwordx4 v1, s[40:43], s87 offen offset:0 lds
    buffer_load_dwordx4 v2, s[40:43], s87 offen offset:1024 lds
    buffer_load_dwordx4 v3, s[40:43], s87 offen offset:2048 lds
    buffer_load_dwordx4 v4, s[40:43], s87 offen offset:3072 lds
    s_add_u32 m0, s78, 12288
    s_mul_i32 s87, s74, 196608
    s_add_u32 s87, s87, s76
    buffer_load_dwordx4 v5, s[48:51], s87 offen offset:0 lds
    buffer_load_dwordx4 v6, s[48:51], s87 offen offset:1024 lds
    buffer_load_dwordx4 v7, s[48:51], s87 offen offset:2048 lds
    s_add_u32 m0, s79, 4
    s_mov_b64 exec, 1
    global_load_lds_dword v23, s[38:39]
    s_mov_b64 exec, -1
    s_lshr_b64 s[0:1], s[0:1], 4
    s_and_b32 s74, s0, 15
    s_mov_b32 s56, 0x05040100
    s_mov_b32 s57, 0x07060302
    s_waitcnt vmcnt(19)
    ds_read_b32 v19, v31 offset:64
    s_add_u32 m0, s77, 8192
    s_lshl_b32 s87, s74, 7
    s_add_u32 s87, s87, s75
    buffer_load_dwordx4 v1, s[40:43], s87 offen offset:0 lds
    buffer_load_dwordx4 v2, s[40:43], s87 offen offset:1024 lds
    s_waitcnt lgkmcnt(0)
    v_cmp_eq_u32 vcc, 0, v19
    s_cbranch_vccnz .rt_1
.rb_2:
    ds_read_b128 v[80:83], v10 offset:0
    ds_read_b64_tr_b16 v[96:97], v14 offset:0
    ds_read_b64_tr_b16 v[98:99], v14 offset:256
    ds_read_b64_tr_b16 v[100:101], v14 offset:1024
    buffer_load_dwordx4 v3, s[40:43], s87 offen offset:2048 lds
    ds_read_b64_tr_b16 v[102:103], v14 offset:1280
    ds_read_b64_tr_b16 v[104:105], v14 offset:2048
    ds_read_b64_tr_b16 v[106:107], v14 offset:2304
    ds_read_b128 v[84:87], v11 offset:0
    buffer_load_dwordx4 v4, s[40:43], s87 offen offset:3072 lds
    ds_read_b64_tr_b16 v[108:109], v15 offset:0
    ds_read_b64_tr_b16 v[110:111], v15 offset:256
    ds_read_b64_tr_b16 v[112:113], v15 offset:1024
    ds_read_b64_tr_b16 v[114:115], v15 offset:1280
    s_add_u32 m0, s78, 24576
    s_mul_i32 s87, s74, 196608
    s_add_u32 s87, s87, s76
    s_nop 0
    buffer_load_dwordx4 v5, s[48:51], s87 offen offset:0 lds
    ds_read_b64_tr_b16 v[116:117], v15 offset:2048
    ds_read_b64_tr_b16 v[118:119], v15 offset:2304
    ds_read_b128 v[88:91], v12 offset:0
    ds_read_b64_tr_b16 v[120:121], v16 offset:0
    buffer_load_dwordx4 v6, s[48:51], s87 offen offset:1024 lds
    ds_read_b64_tr_b16 v[122:123], v16 offset:256
    ds_read_b64_tr_b16 v[124:125], v16 offset:1024
    ds_read_b64_tr_b16 v[126:127], v16 offset:1280
    ds_read_b64_tr_b16 v[128:129], v16 offset:2048
    buffer_load_dwordx4 v7, s[48:51], s87 offen offset:2048 lds
    ds_read_b64_tr_b16 v[130:131], v16 offset:2304
    ds_read_b128 v[92:95], v13 offset:0
    ds_read_b64_tr_b16 v[132:133], v17 offset:0
    ds_read_b64_tr_b16 v[134:135], v17 offset:256
    s_add_u32 m0, s79, 8
    s_mov_b64 exec, 1
    global_load_lds_dword v23, s[38:39]
    s_mov_b64 exec, -1
    s_lshr_b64 s[0:1], s[0:1], 4
    s_and_b32 s74, s0, 15
    ds_read_b64_tr_b16 v[136:137], v17 offset:1024
    ds_read_b64_tr_b16 v[138:139], v17 offset:1280
    ds_read_b64_tr_b16 v[140:141], v17 offset:2048
    ds_read_b64_tr_b16 v[142:143], v17 offset:2304
    s_waitcnt lgkmcnt(15)
    v_mfma_f32_16x16x32_bf16 v[240:243], v[232:235], v[96:99], 0
    v_mfma_f32_16x16x32_bf16 v[244:247], v[232:235], v[104:107], 0
    v_mfma_f32_16x16x32_bf16 v[240:243], v[236:239], v[100:103], v[240:243]
    v_mfma_f32_32x32x16_bf16 v[32:47], v[96:99], v[80:83], 0
    ds_read_b32 v19, v31 offset:68
    s_lshr_b32 s70, s60, 1
    s_lshl_b32 s70, s70, 3
    s_and_b32 s12, s61, 7
    s_add_u32 s64, s70, s12
    s_and_b32 s70, s60, 1
    v_mfma_f32_32x32x16_bf16 v[48:63], v[100:103], v[80:83], 0
    s_waitcnt vmcnt(16)
    v_perm_b32 v248, v221, v220, s56
    v_perm_b32 v249, v223, v222, s56
    v_perm_b32 v250, v225, v224, s56
    v_perm_b32 v251, v227, v226, s56
    buffer_store_dwordx4 v[248:251], v28, s[44:47], s58 offen sc1
    v_mfma_f32_32x32x16_bf16 v[64:79], v[104:107], v[80:83], 0
    v_perm_b32 v252, v221, v220, s57
    v_perm_b32 v253, v223, v222, s57
    v_perm_b32 v254, v225, v224, s57
    v_perm_b32 v255, v227, v226, s57
    buffer_store_dwordx4 v[252:255], v28, s[44:47], s59 offen sc1
    s_waitcnt lgkmcnt(0)
    v_cmp_eq_u32 vcc, 0, v19
    s_cbranch_vccnz .rt_3
.rb_4:
    v_mfma_f32_32x32x16_bf16 v[32:47], v[108:111], v[84:87], v[32:47]
    s_add_u32 m0, s77, 0
    s_lshl_b32 s87, s74, 7
    s_add_u32 s87, s87, s75
    buffer_load_dwordx4 v1, s[40:43], s87 offen offset:0 lds
    ds_read_b128 v[144:147], v10 offset:4096
    ds_read_b64_tr_b16 v[160:161], v14 offset:12288
    ds_read_b64_tr_b16 v[162:163], v14 offset:12544
    ds_read_b64_tr_b16 v[164:165], v14 offset:13312
    v_mfma_f32_32x32x16_bf16 v[48:63], v[112:115], v[84:87], v[48:63]
    buffer_load_dwordx4 v2, s[40:43], s87 offen offset:1024 lds
    ds_read_b64_tr_b16 v[166:167], v14 offset:13568
    ds_read_b64_tr_b16 v[168:169], v14 offset:14336
    ds_read_b64_tr_b16 v[170:171], v14 offset:14592
    v_mfma_f32_32x32x16_bf16 v[64:79], v[116:119], v[84:87], v[64:79]
    buffer_load_dwordx4 v3, s[40:43], s87 offen offset:2048 lds
    ds_read_b128 v[148:151], v11 offset:4096
    ds_read_b64_tr_b16 v[172:173], v15 offset:12288
    ds_read_b64_tr_b16 v[174:175], v15 offset:12544
    v_mfma_f32_32x32x16_bf16 v[32:47], v[120:123], v[88:91], v[32:47]
    buffer_load_dwordx4 v4, s[40:43], s87 offen offset:3072 lds
    ds_read_b64_tr_b16 v[176:177], v15 offset:13312
    ds_read_b64_tr_b16 v[178:179], v15 offset:13568
    ds_read_b64_tr_b16 v[180:181], v15 offset:14336
    ds_read_b64_tr_b16 v[182:183], v15 offset:14592
    v_mfma_f32_32x32x16_bf16 v[48:63], v[124:127], v[88:91], v[48:63]
    s_add_u32 m0, s78, 36864
    s_mul_i32 s87, s74, 196608
    s_add_u32 s87, s87, s76
    s_nop 0
    buffer_load_dwordx4 v5, s[48:51], s87 offen offset:0 lds
    ds_read_b128 v[152:155], v12 offset:4096
    ds_read_b64_tr_b16 v[184:185], v16 offset:12288
    ds_read_b64_tr_b16 v[186:187], v16 offset:12544
    v_mfma_f32_32x32x16_bf16 v[64:79], v[128:131], v[88:91], v[64:79]
    buffer_load_dwordx4 v6, s[48:51], s87 offen offset:1024 lds
    ds_read_b64_tr_b16 v[188:189], v16 offset:13312
    ds_read_b64_tr_b16 v[190:191], v16 offset:13568
    ds_read_b64_tr_b16 v[192:193], v16 offset:14336
    v_mfma_f32_32x32x16_bf16 v[32:47], v[132:135], v[92:95], v[32:47]
    buffer_load_dwordx4 v7, s[48:51], s87 offen offset:2048 lds
    ds_read_b64_tr_b16 v[194:195], v16 offset:14592
    ds_read_b128 v[156:159], v13 offset:4096
    ds_read_b64_tr_b16 v[196:197], v17 offset:12288
    ds_read_b64_tr_b16 v[198:199], v17 offset:12544
    v_mfma_f32_32x32x16_bf16 v[48:63], v[136:139], v[92:95], v[48:63]
    s_add_u32 m0, s79, 12
    s_mov_b64 exec, 1
    global_load_lds_dword v23, s[38:39]
    s_mov_b64 exec, -1
    s_lshr_b64 s[0:1], s[0:1], 4
    s_and_b32 s74, s0, 15
    ds_read_b64_tr_b16 v[200:201], v17 offset:13312
    ds_read_b64_tr_b16 v[202:203], v17 offset:13568
    ds_read_b64_tr_b16 v[204:205], v17 offset:14336
    v_mfma_f32_32x32x16_bf16 v[64:79], v[140:143], v[92:95], v[64:79]
    ds_read_b64_tr_b16 v[206:207], v17 offset:14592
    s_waitcnt lgkmcnt(15)
    v_mfma_f32_16x16x32_bf16 v[240:243], v[232:235], v[160:163], v[240:243]
    v_mfma_f32_16x16x32_bf16 v[244:247], v[232:235], v[168:171], v[244:247]
    v_mfma_f32_16x16x32_bf16 v[240:243], v[236:239], v[164:167], v[240:243]
    v_mfma_f32_32x32x16_bf16 v[32:47], v[160:163], v[144:147], v[32:47]
    ds_read_b32 v19, v31 offset:72
    s_lshl_b32 s70, s70, 2
    s_lshr_b32 s12, s61, 3
    s_add_u32 s65, s70, s12
    s_lshl_b32 s70, s72, 4
    v_mov_b32 v8, s70
    v_mfma_f32_32x32x16_bf16 v[48:63], v[164:167], v[144:147], v[48:63]
    v_lshlrev_b32 v9, 4, v9
    v_add_u32 v29, 4096, v28
    v_lshlrev_b32_e64 v211, 4, v211
    v_add_u32 v211, 102400, v211
    v_bfe_u32 v208, v0, 3, 2
    v_mfma_f32_32x32x16_bf16 v[64:79], v[168:171], v[144:147], v[64:79]
    v_lshlrev_b32 v208, 7, v208
    v_bfe_u32 v22, v0, 2, 1
    v_lshl_add_u32 v208, v22, 12, v208
    v_and_b32 v22, 3, v0
    v_lshl_add_u32 v208, v22, 4, v208
    s_waitcnt lgkmcnt(0)
    v_cmp_eq_u32 vcc, 0, v19
    s_cbranch_vccnz .rt_5
.rb_6:
    v_mfma_f32_32x32x16_bf16 v[32:47], v[172:175], v[148:151], v[32:47]
    s_add_u32 m0, s77, 4096
    s_lshl_b32 s87, s74, 7
    s_add_u32 s87, s87, s75
    s_nop 0
    buffer_load_dwordx4 v1, s[40:43], s87 offen offset:0 lds
    ds_read_b128 v[80:83], v10 offset:8192
    ds_read_b64_tr_b16 v[96:97], v14 offset:24576
    ds_read_b64_tr_b16 v[98:99], v14 offset:24832
    ds_read_b64_tr_b16 v[100:101], v14 offset:25600
    v_mfma_f32_32x32x16_bf16 v[48:63], v[176:179], v[148:151], v[48:63]
    buffer_load_dwordx4 v2, s[40:43], s87 offen offset:1024 lds
    ds_read_b64_tr_b16 v[102:103], v14 offset:25856
    ds_read_b64_tr_b16 v[104:105], v14 offset:26624
    ds_read_b64_tr_b16 v[106:107], v14 offset:26880
    v_mfma_f32_32x32x16_bf16 v[64:79], v[180:183], v[148:151], v[64:79]
    buffer_load_dwordx4 v3, s[40:43], s87 offen offset:2048 lds
    ds_read_b128 v[84:87], v11 offset:8192
    ds_read_b64_tr_b16 v[108:109], v15 offset:24576
    ds_read_b64_tr_b16 v[110:111], v15 offset:24832
    v_mfma_f32_32x32x16_bf16 v[32:47], v[184:187], v[152:155], v[32:47]
    buffer_load_dwordx4 v4, s[40:43], s87 offen offset:3072 lds
    ds_read_b64_tr_b16 v[112:113], v15 offset:25600
    ds_read_b64_tr_b16 v[114:115], v15 offset:25856
    ds_read_b64_tr_b16 v[116:117], v15 offset:26624
    ds_read_b64_tr_b16 v[118:119], v15 offset:26880
    v_mfma_f32_32x32x16_bf16 v[48:63], v[188:191], v[152:155], v[48:63]
    s_add_u32 m0, s78, 49152
    s_mul_i32 s87, s74, 196608
    s_add_u32 s87, s87, s76
    s_nop 0
    buffer_load_dwordx4 v5, s[48:51], s87 offen offset:0 lds
    ds_read_b128 v[88:91], v12 offset:8192
    ds_read_b64_tr_b16 v[120:121], v16 offset:24576
    ds_read_b64_tr_b16 v[122:123], v16 offset:24832
    v_mfma_f32_32x32x16_bf16 v[64:79], v[192:195], v[152:155], v[64:79]
    buffer_load_dwordx4 v6, s[48:51], s87 offen offset:1024 lds
    ds_read_b64_tr_b16 v[124:125], v16 offset:25600
    ds_read_b64_tr_b16 v[126:127], v16 offset:25856
    ds_read_b64_tr_b16 v[128:129], v16 offset:26624
    v_mfma_f32_32x32x16_bf16 v[32:47], v[196:199], v[156:159], v[32:47]
    buffer_load_dwordx4 v7, s[48:51], s87 offen offset:2048 lds
    ds_read_b64_tr_b16 v[130:131], v16 offset:26880
    ds_read_b128 v[92:95], v13 offset:8192
    ds_read_b64_tr_b16 v[132:133], v17 offset:24576
    ds_read_b64_tr_b16 v[134:135], v17 offset:24832
    v_mfma_f32_32x32x16_bf16 v[48:63], v[200:203], v[156:159], v[48:63]
    s_add_u32 m0, s79, 16
    s_mov_b64 exec, 1
    global_load_lds_dword v23, s[38:39]
    s_mov_b64 exec, -1
    s_lshr_b64 s[0:1], s[0:1], 4
    s_and_b32 s74, s0, 15
    ds_read_b64_tr_b16 v[136:137], v17 offset:25600
    ds_read_b64_tr_b16 v[138:139], v17 offset:25856
    ds_read_b64_tr_b16 v[140:141], v17 offset:26624
    v_mfma_f32_32x32x16_bf16 v[64:79], v[204:207], v[156:159], v[64:79]
    ds_read_b64_tr_b16 v[142:143], v17 offset:26880
    s_waitcnt lgkmcnt(15)
    v_mfma_f32_16x16x32_bf16 v[240:243], v[232:235], v[96:99], v[240:243]
    v_mfma_f32_16x16x32_bf16 v[244:247], v[232:235], v[104:107], v[244:247]
    v_mfma_f32_16x16x32_bf16 v[240:243], v[236:239], v[100:103], v[240:243]
    v_mfma_f32_32x32x16_bf16 v[32:47], v[96:99], v[80:83], v[32:47]
    ds_read_b32 v19, v31 offset:76
    s_lshr_b32 s70, s62, 2
    s_lshl_b32 s70, s70, 13
    s_and_b32 s12, s62, 2
    s_lshl_b32 s12, s12, 10
    s_add_u32 s70, s70, s12
    v_mfma_f32_32x32x16_bf16 v[48:63], v[100:103], v[80:83], v[48:63]
    s_and_b32 s12, s62, 1
    s_lshl_b32 s12, s12, 6
    s_add_u32 s70, s70, s12
    s_lshl_b32 s12, s72, 9
    s_add_u32 s70, s70, s12
    v_mfma_f32_32x32x16_bf16 v[64:79], v[104:107], v[80:83], v[64:79]
    s_add_u32 s83, s70, 16384
    s_lshl_b32 s70, s65, 7
    v_and_b32 v22, 16, v0
    v_lshl_add_u32 v22, v22, 2, s70
    s_lshr_b32 s70, s65, 1
    s_waitcnt lgkmcnt(0)
    v_cmp_eq_u32 vcc, 0, v19
    s_cbranch_vccnz .rt_7
.rb_8:
    v_mfma_f32_32x32x16_bf16 v[32:47], v[108:111], v[84:87], v[32:47]
    s_add_u32 m0, s77, 8192
    s_lshl_b32 s87, s74, 7
    s_add_u32 s87, s87, s75
    buffer_load_dwordx4 v1, s[40:43], s87 offen offset:0 lds
    ds_read_b128 v[144:147], v10 offset:0
    ds_read_b64_tr_b16 v[160:161], v14 offset:36864
    ds_read_b64_tr_b16 v[162:163], v14 offset:37120
    ds_read_b64_tr_b16 v[164:165], v14 offset:37888
    v_mfma_f32_32x32x16_bf16 v[48:63], v[112:115], v[84:87], v[48:63]
    buffer_load_dwordx4 v2, s[40:43], s87 offen offset:1024 lds
    ds_read_b64_tr_b16 v[166:167], v14 offset:38144
    ds_read_b64_tr_b16 v[168:169], v14 offset:38912
    ds_read_b64_tr_b16 v[170:171], v14 offset:39168
    v_mfma_f32_32x32x16_bf16 v[64:79], v[116:119], v[84:87], v[64:79]
    buffer_load_dwordx4 v3, s[40:43], s87 offen offset:2048 lds
    ds_read_b128 v[148:151], v11 offset:0
    ds_read_b64_tr_b16 v[172:173], v15 offset:36864
    ds_read_b64_tr_b16 v[174:175], v15 offset:37120
    v_mfma_f32_32x32x16_bf16 v[32:47], v[120:123], v[88:91], v[32:47]
    buffer_load_dwordx4 v4, s[40:43], s87 offen offset:3072 lds
    ds_read_b64_tr_b16 v[176:177], v15 offset:37888
    ds_read_b64_tr_b16 v[178:179], v15 offset:38144
    ds_read_b64_tr_b16 v[180:181], v15 offset:38912
    ds_read_b64_tr_b16 v[182:183], v15 offset:39168
    v_mfma_f32_32x32x16_bf16 v[48:63], v[124:127], v[88:91], v[48:63]
    s_add_u32 m0, s78, 0
    s_mul_i32 s87, s74, 196608
    s_add_u32 s87, s87, s76
    buffer_load_dwordx4 v5, s[48:51], s87 offen offset:0 lds
    ds_read_b128 v[152:155], v12 offset:0
    ds_read_b64_tr_b16 v[184:185], v16 offset:36864
    ds_read_b64_tr_b16 v[186:187], v16 offset:37120
    v_mfma_f32_32x32x16_bf16 v[64:79], v[128:131], v[88:91], v[64:79]
    buffer_load_dwordx4 v6, s[48:51], s87 offen offset:1024 lds
    ds_read_b64_tr_b16 v[188:189], v16 offset:37888
    ds_read_b64_tr_b16 v[190:191], v16 offset:38144
    ds_read_b64_tr_b16 v[192:193], v16 offset:38912
    v_mfma_f32_32x32x16_bf16 v[32:47], v[132:135], v[92:95], v[32:47]
    buffer_load_dwordx4 v7, s[48:51], s87 offen offset:2048 lds
    ds_read_b64_tr_b16 v[194:195], v16 offset:39168
    ds_read_b128 v[156:159], v13 offset:0
    ds_read_b64_tr_b16 v[196:197], v17 offset:36864
    ds_read_b64_tr_b16 v[198:199], v17 offset:37120
    v_mfma_f32_32x32x16_bf16 v[48:63], v[136:139], v[92:95], v[48:63]
    s_add_u32 m0, s79, 20
    s_mov_b64 exec, 1
    global_load_lds_dword v23, s[38:39]
    s_mov_b64 exec, -1
    s_lshr_b64 s[0:1], s[0:1], 4
    s_and_b32 s74, s0, 15
    ds_read_b64_tr_b16 v[200:201], v17 offset:37888
    ds_read_b64_tr_b16 v[202:203], v17 offset:38144
    ds_read_b64_tr_b16 v[204:205], v17 offset:38912
    v_mfma_f32_32x32x16_bf16 v[64:79], v[140:143], v[92:95], v[64:79]
    ds_read_b64_tr_b16 v[206:207], v17 offset:39168
    s_waitcnt lgkmcnt(15)
    v_mfma_f32_16x16x32_bf16 v[240:243], v[232:235], v[160:163], v[240:243]
    v_mfma_f32_16x16x32_bf16 v[244:247], v[232:235], v[168:171], v[244:247]
    v_mfma_f32_16x16x32_bf16 v[240:243], v[236:239], v[164:167], v[240:243]
    v_mfma_f32_32x32x16_bf16 v[32:47], v[160:163], v[144:147], v[32:47]
    ds_read_b32 v21, v20
    ds_read_b32 v19, v31 offset:80
    s_lshl_b32 s70, s70, 6
    s_addk_i32 s70, 1024
    v_mov_b32 v213, s70
    v_cmp_gt_u32 vcc, 32, v0
    v_and_b32 v209, 15, v0
    v_min_u32_e64 v209, 11, v209
    v_cndmask_b32 v22, v213, v22, vcc
    v_lshl_add_u32 v209, v209, 2, v22
    v_mfma_f32_32x32x16_bf16 v[48:63], v[164:167], v[144:147], v[48:63]
    s_mul_i32 s73, s72, 1280
    s_add_u32 s73, s73, 4096
    s_lshl_b32 s70, s72, 2
    s_add_u32 s70, s70, 102400
    v_lshl_add_u32 v210, v0, 4, s70
    v_mfma_f32_32x32x16_bf16 v[64:79], v[168:171], v[144:147], v[64:79]
    s_mul_i32 s12, s65, 245760
    s_mul_i32 s70, s72, 15360
    s_add_u32 s12, s12, s70
    s_add_u32 s12, s12, 4194304
    s_and_b32 s82, s64, 3
    s_waitcnt lgkmcnt(0)
    v_cmp_eq_u32 vcc, 0, v19
    s_cbranch_vccnz .rt_9
.rb_10:
    v_cmp_eq_u32 vcc, 0, v21
    s_cbranch_vccnz .rt_11
.rb_12:
    v_readfirstlane_b32 s67, v21
    s_waitcnt vmcnt(24)
    s_mov_b64 exec, 1
    buffer_store_dword v21, off, s[44:47], s3 sc1
    s_mov_b64 exec, -1
    v_mfma_f32_32x32x16_bf16 v[32:47], v[172:175], v[148:151], v[32:47]
    s_add_u32 m0, s77, 0
    s_lshl_b32 s87, s74, 7
    s_add_u32 s87, s87, s75
    s_nop 0
    buffer_load_dwordx4 v1, s[40:43], s87 offen offset:0 lds
    ds_read_b128 v[80:83], v10 offset:4096
    ds_read_b64_tr_b16 v[96:97], v14 offset:49152
    ds_read_b64_tr_b16 v[98:99], v14 offset:49408
    ds_read_b64_tr_b16 v[100:101], v14 offset:50176
    v_mfma_f32_32x32x16_bf16 v[48:63], v[176:179], v[148:151], v[48:63]
    buffer_load_dwordx4 v2, s[40:43], s87 offen offset:1024 lds
    ds_read_b64_tr_b16 v[102:103], v14 offset:50432
    ds_read_b64_tr_b16 v[104:105], v14 offset:51200
    ds_read_b64_tr_b16 v[106:107], v14 offset:51456
    v_mfma_f32_32x32x16_bf16 v[64:79], v[180:183], v[148:151], v[64:79]
    buffer_load_dwordx4 v3, s[40:43], s87 offen offset:2048 lds
    ds_read_b128 v[84:87], v11 offset:4096
    ds_read_b64_tr_b16 v[108:109], v15 offset:49152
    ds_read_b64_tr_b16 v[110:111], v15 offset:49408
    v_mfma_f32_32x32x16_bf16 v[32:47], v[184:187], v[152:155], v[32:47]
    buffer_load_dwordx4 v4, s[40:43], s87 offen offset:3072 lds
    ds_read_b64_tr_b16 v[112:113], v15 offset:50176
    ds_read_b64_tr_b16 v[114:115], v15 offset:50432
    ds_read_b64_tr_b16 v[116:117], v15 offset:51200
    ds_read_b64_tr_b16 v[118:119], v15 offset:51456
    v_mfma_f32_32x32x16_bf16 v[48:63], v[188:191], v[152:155], v[48:63]
    s_add_u32 m0, s78, 12288
    s_mul_i32 s87, s74, 196608
    s_add_u32 s87, s87, s76
    s_nop 0
    buffer_load_dwordx4 v5, s[48:51], s87 offen offset:0 lds
    ds_read_b128 v[88:91], v12 offset:4096
    ds_read_b64_tr_b16 v[120:121], v16 offset:49152
    ds_read_b64_tr_b16 v[122:123], v16 offset:49408
    v_mfma_f32_32x32x16_bf16 v[64:79], v[192:195], v[152:155], v[64:79]
    buffer_load_dwordx4 v6, s[48:51], s87 offen offset:1024 lds
    ds_read_b64_tr_b16 v[124:125], v16 offset:50176
    ds_read_b64_tr_b16 v[126:127], v16 offset:50432
    ds_read_b64_tr_b16 v[128:129], v16 offset:51200
    v_mfma_f32_32x32x16_bf16 v[32:47], v[196:199], v[156:159], v[32:47]
    buffer_load_dwordx4 v7, s[48:51], s87 offen offset:2048 lds
    ds_read_b64_tr_b16 v[130:131], v16 offset:51456
    ds_read_b128 v[92:95], v13 offset:4096
    ds_read_b64_tr_b16 v[132:133], v17 offset:49152
    ds_read_b64_tr_b16 v[134:135], v17 offset:49408
    v_mfma_f32_32x32x16_bf16 v[48:63], v[200:203], v[156:159], v[48:63]
    s_add_u32 m0, s79, 24
    s_mov_b64 exec, 1
    global_load_lds_dword v23, s[38:39]
    s_mov_b64 exec, -1
    s_lshr_b64 s[0:1], s[0:1], 4
    s_and_b32 s74, s0, 15
    ds_read_b64_tr_b16 v[136:137], v17 offset:50176
    ds_read_b64_tr_b16 v[138:139], v17 offset:50432
    ds_read_b64_tr_b16 v[140:141], v17 offset:51200
    v_mfma_f32_32x32x16_bf16 v[64:79], v[204:207], v[156:159], v[64:79]
    ds_read_b64_tr_b16 v[142:143], v17 offset:51456
    s_waitcnt lgkmcnt(15)
    v_mfma_f32_16x16x32_bf16 v[240:243], v[232:235], v[96:99], v[240:243]
    v_mfma_f32_16x16x32_bf16 v[244:247], v[232:235], v[104:107], v[244:247]
    v_mfma_f32_16x16x32_bf16 v[240:243], v[236:239], v[100:103], v[240:243]
    v_mfma_f32_32x32x16_bf16 v[32:47], v[96:99], v[80:83], v[32:47]
    ds_read_b32 v19, v31 offset:84
    s_and_b32 s70, s65, 0
    s_xor_b32 s82, s82, s70
    s_xor_b32 s70, s82, 0
    s_mul_i32 s70, s70, 61440
    s_add_u32 s4, s12, s70
    v_mfma_f32_32x32x16_bf16 v[48:63], v[100:103], v[80:83], v[48:63]
    s_xor_b32 s70, s82, 1
    s_mul_i32 s70, s70, 61440
    s_add_u32 s5, s12, s70
    s_xor_b32 s70, s82, 2
    s_mul_i32 s70, s70, 61440
    v_mfma_f32_32x32x16_bf16 v[64:79], v[104:107], v[80:83], v[64:79]
    s_add_u32 s6, s12, s70
    s_xor_b32 s70, s82, 3
    s_mul_i32 s70, s70, 61440
    s_add_u32 s7, s12, s70
    v_bfe_u32 v22, v0, 4, 1
    s_waitcnt lgkmcnt(0)
    v_cmp_eq_u32 vcc, 0, v19
    s_cbranch_vccnz .rt_13
.rb_14:
    v_mfma_f32_32x32x16_bf16 v[32:47], v[108:111], v[84:87], v[32:47]
    s_add_u32 m0, s77, 4096
    s_lshl_b32 s87, s74, 7
    s_add_u32 s87, s87, s75
    s_nop 0
    buffer_load_dwordx4 v1, s[40:43], s87 offen offset:0 lds
    ds_read_b128 v[144:147], v10 offset:8192
    ds_read_b64_tr_b16 v[160:161], v14 offset:0
    ds_read_b64_tr_b16 v[162:163], v14 offset:256
    ds_read_b64_tr_b16 v[164:165], v14 offset:1024
    v_mfma_f32_32x32x16_bf16 v[48:63], v[112:115], v[84:87], v[48:63]
    buffer_load_dwordx4 v2, s[40:43], s87 offen offset:1024 lds
    ds_read_b64_tr_b16 v[166:167], v14 offset:1280
    ds_read_b64_tr_b16 v[168:169], v14 offset:2048
    ds_read_b64_tr_b16 v[170:171], v14 offset:2304
    v_mfma_f32_32x32x16_bf16 v[64:79], v[116:119], v[84:87], v[64:79]
    buffer_load_dwordx4 v3, s[40:43], s87 offen offset:2048 lds
    ds_read_b128 v[148:151], v11 offset:8192
    ds_read_b64_tr_b16 v[172:173], v15 offset:0
    ds_read_b64_tr_b16 v[174:175], v15 offset:256
    v_mfma_f32_32x32x16_bf16 v[32:47], v[120:123], v[88:91], v[32:47]
    buffer_load_dwordx4 v4, s[40:43], s87 offen offset:3072 lds
    ds_read_b64_tr_b16 v[176:177], v15 offset:1024
    ds_read_b64_tr_b16 v[178:179], v15 offset:1280
    ds_read_b64_tr_b16 v[180:181], v15 offset:2048
    ds_read_b64_tr_b16 v[182:183], v15 offset:2304
    v_mfma_f32_32x32x16_bf16 v[48:63], v[124:127], v[88:91], v[48:63]
    s_add_u32 m0, s78, 24576
    s_mul_i32 s87, s74, 196608
    s_add_u32 s87, s87, s76
    s_nop 0
    buffer_load_dwordx4 v5, s[48:51], s87 offen offset:0 lds
    ds_read_b128 v[152:155], v12 offset:8192
    ds_read_b64_tr_b16 v[184:185], v16 offset:0
    ds_read_b64_tr_b16 v[186:187], v16 offset:256
    v_mfma_f32_32x32x16_bf16 v[64:79], v[128:131], v[88:91], v[64:79]
    buffer_load_dwordx4 v6, s[48:51], s87 offen offset:1024 lds
    ds_read_b64_tr_b16 v[188:189], v16 offset:1024
    ds_read_b64_tr_b16 v[190:191], v16 offset:1280
    ds_read_b64_tr_b16 v[192:193], v16 offset:2048
    v_mfma_f32_32x32x16_bf16 v[32:47], v[132:135], v[92:95], v[32:47]
    buffer_load_dwordx4 v7, s[48:51], s87 offen offset:2048 lds
    ds_read_b64_tr_b16 v[194:195], v16 offset:2304
    ds_read_b128 v[156:159], v13 offset:8192
    ds_read_b64_tr_b16 v[196:197], v17 offset:0
    ds_read_b64_tr_b16 v[198:199], v17 offset:256
    v_mfma_f32_32x32x16_bf16 v[48:63], v[136:139], v[92:95], v[48:63]
    s_add_u32 m0, s79, 28
    s_mov_b64 exec, 1
    global_load_lds_dword v23, s[38:39]
    s_mov_b64 exec, -1
    s_lshr_b64 s[0:1], s[0:1], 4
    s_and_b32 s74, s0, 15
    ds_read_b64_tr_b16 v[200:201], v17 offset:1024
    ds_read_b64_tr_b16 v[202:203], v17 offset:1280
    ds_read_b64_tr_b16 v[204:205], v17 offset:2048
    v_mfma_f32_32x32x16_bf16 v[64:79], v[140:143], v[92:95], v[64:79]
    ds_read_b64_tr_b16 v[206:207], v17 offset:2304
    s_waitcnt lgkmcnt(15)
    v_mfma_f32_16x16x32_bf16 v[240:243], v[232:235], v[160:163], v[240:243]
    v_mfma_f32_16x16x32_bf16 v[244:247], v[232:235], v[168:171], v[244:247]
    v_mfma_f32_16x16x32_bf16 v[240:243], v[236:239], v[164:167], v[240:243]
    v_mfma_f32_32x32x16_bf16 v[32:47], v[160:163], v[144:147], v[32:47]
    ds_read_b32 v19, v31 offset:88
    v_lshlrev_b32 v22, 10, v22
    v_lshrrev_b32 v212, 5, v0
    v_lshl_add_u32 v22, v212, 8, v22
    v_and_b32 v212, 15, v0
    v_lshl_add_u32 v212, v212, 4, v22
    v_mfma_f32_32x32x16_bf16 v[48:63], v[164:167], v[144:147], v[48:63]
    s_lshl_b32 s70, s62, 1
    s_lshr_b32 s12, s72, 1
    s_add_u32 s86, s70, s12
    s_mul_i32 s80, s86, 48
    s_mul_i32 s70, s63, 3
    v_mfma_f32_32x32x16_bf16 v[64:79], v[168:171], v[144:147], v[64:79]
    s_add_u32 s80, s80, s70
    s_lshl_b32 s80, s80, 12
    s_and_b32 s70, s72, 1
    s_lshl_b32 s70, s70, 11
    s_add_u32 s80, s80, s70
    s_waitcnt lgkmcnt(0)
    v_cmp_eq_u32 vcc, 0, v19
    s_cbranch_vccnz .rt_15
.rb_16:
    v_mfma_f32_32x32x16_bf16 v[32:47], v[172:175], v[148:151], v[32:47]
    s_add_u32 m0, s77, 8192
    s_lshl_b32 s87, s74, 7
    s_add_u32 s87, s87, s75
    buffer_load_dwordx4 v1, s[40:43], s87 offen offset:0 lds
    ds_read_b128 v[80:83], v10 offset:0
    ds_read_b64_tr_b16 v[96:97], v14 offset:12288
    ds_read_b64_tr_b16 v[98:99], v14 offset:12544
    ds_read_b64_tr_b16 v[100:101], v14 offset:13312
    v_mfma_f32_32x32x16_bf16 v[48:63], v[176:179], v[148:151], v[48:63]
    buffer_load_dwordx4 v2, s[40:43], s87 offen offset:1024 lds
    ds_read_b64_tr_b16 v[102:103], v14 offset:13568
    ds_read_b64_tr_b16 v[104:105], v14 offset:14336
    ds_read_b64_tr_b16 v[106:107], v14 offset:14592
    v_mfma_f32_32x32x16_bf16 v[64:79], v[180:183], v[148:151], v[64:79]
    buffer_load_dwordx4 v3, s[40:43], s87 offen offset:2048 lds
    ds_read_b128 v[84:87], v11 offset:0
    ds_read_b64_tr_b16 v[108:109], v15 offset:12288
    ds_read_b64_tr_b16 v[110:111], v15 offset:12544
    v_mfma_f32_32x32x16_bf16 v[32:47], v[184:187], v[152:155], v[32:47]
    buffer_load_dwordx4 v4, s[40:43], s87 offen offset:3072 lds
    ds_read_b64_tr_b16 v[112:113], v15 offset:13312
    ds_read_b64_tr_b16 v[114:115], v15 offset:13568
    ds_read_b64_tr_b16 v[116:117], v15 offset:14336
    ds_read_b64_tr_b16 v[118:119], v15 offset:14592
    v_mfma_f32_32x32x16_bf16 v[48:63], v[188:191], v[152:155], v[48:63]
    s_add_u32 m0, s78, 36864
    s_mul_i32 s87, s74, 196608
    s_add_u32 s87, s87, s76
    s_nop 0
    buffer_load_dwordx4 v5, s[48:51], s87 offen offset:0 lds
    ds_read_b128 v[88:91], v12 offset:0
    ds_read_b64_tr_b16 v[120:121], v16 offset:12288
    ds_read_b64_tr_b16 v[122:123], v16 offset:12544
    v_mfma_f32_32x32x16_bf16 v[64:79], v[192:195], v[152:155], v[64:79]
    buffer_load_dwordx4 v6, s[48:51], s87 offen offset:1024 lds
    ds_read_b64_tr_b16 v[124:125], v16 offset:13312
    ds_read_b64_tr_b16 v[126:127], v16 offset:13568
    ds_read_b64_tr_b16 v[128:129], v16 offset:14336
    v_mfma_f32_32x32x16_bf16 v[32:47], v[196:199], v[156:159], v[32:47]
    buffer_load_dwordx4 v7, s[48:51], s87 offen offset:2048 lds
    ds_read_b64_tr_b16 v[130:131], v16 offset:14592
    ds_read_b128 v[92:95], v13 offset:0
    ds_read_b64_tr_b16 v[132:133], v17 offset:12288
    ds_read_b64_tr_b16 v[134:135], v17 offset:12544
    v_mfma_f32_32x32x16_bf16 v[48:63], v[200:203], v[156:159], v[48:63]
    s_add_u32 m0, s79, 32
    s_mov_b64 exec, 1
    global_load_lds_dword v23, s[38:39]
    s_mov_b64 exec, -1
    s_lshr_b64 s[0:1], s[0:1], 4
    s_and_b32 s74, s0, 15
    ds_read_b64_tr_b16 v[136:137], v17 offset:13312
    ds_read_b64_tr_b16 v[138:139], v17 offset:13568
    ds_read_b64_tr_b16 v[140:141], v17 offset:14336
    v_mfma_f32_32x32x16_bf16 v[64:79], v[204:207], v[156:159], v[64:79]
    ds_read_b64_tr_b16 v[142:143], v17 offset:14592
    s_waitcnt lgkmcnt(15)
    v_mfma_f32_16x16x32_bf16 v[240:243], v[232:235], v[96:99], v[240:243]
    v_mfma_f32_16x16x32_bf16 v[244:247], v[232:235], v[104:107], v[244:247]
    v_mfma_f32_16x16x32_bf16 v[240:243], v[236:239], v[100:103], v[240:243]
    v_mfma_f32_32x32x16_bf16 v[32:47], v[96:99], v[80:83], v[32:47]
    ds_read_b32 v19, v31 offset:92
    s_add_u32 s80, s80, 6291456
    s_mov_b32 s84, 0xbdd2d3e8
    s_mov_b32 s85, 0xc0135761
    v_mfma_f32_32x32x16_bf16 v[48:63], v[100:103], v[80:83], v[48:63]
    v_mfma_f32_32x32x16_bf16 v[64:79], v[104:107], v[80:83], v[64:79]
    s_waitcnt lgkmcnt(0)
    v_cmp_eq_u32 vcc, 0, v19
    s_cbranch_vccnz .rt_17
.rb_18:
    v_mfma_f32_32x32x16_bf16 v[32:47], v[108:111], v[84:87], v[32:47]
    s_add_u32 m0, s77, 0
    s_lshl_b32 s87, s74, 7
    s_add_u32 s87, s87, s75
    buffer_load_dwordx4 v1, s[40:43], s87 offen offset:0 lds
    ds_read_b128 v[144:147], v10 offset:4096
    ds_read_b64_tr_b16 v[160:161], v14 offset:24576
    ds_read_b64_tr_b16 v[162:163], v14 offset:24832
    ds_read_b64_tr_b16 v[164:165], v14 offset:25600
    v_mfma_f32_32x32x16_bf16 v[48:63], v[112:115], v[84:87], v[48:63]
    buffer_load_dwordx4 v2, s[40:43], s87 offen offset:1024 lds
    ds_read_b64_tr_b16 v[166:167], v14 offset:25856
    ds_read_b64_tr_b16 v[168:169], v14 offset:26624
    ds_read_b64_tr_b16 v[170:171], v14 offset:26880
    v_mfma_f32_32x32x16_bf16 v[64:79], v[116:119], v[84:87], v[64:79]
    buffer_load_dwordx4 v3, s[40:43], s87 offen offset:2048 lds
    ds_read_b128 v[148:151], v11 offset:4096
    ds_read_b64_tr_b16 v[172:173], v15 offset:24576
    ds_read_b64_tr_b16 v[174:175], v15 offset:24832
    v_mfma_f32_32x32x16_bf16 v[32:47], v[120:123], v[88:91], v[32:47]
    buffer_load_dwordx4 v4, s[40:43], s87 offen offset:3072 lds
    ds_read_b64_tr_b16 v[176:177], v15 offset:25600
    ds_read_b64_tr_b16 v[178:179], v15 offset:25856
    ds_read_b64_tr_b16 v[180:181], v15 offset:26624
    ds_read_b64_tr_b16 v[182:183], v15 offset:26880
    v_mfma_f32_32x32x16_bf16 v[48:63], v[124:127], v[88:91], v[48:63]
    s_add_u32 m0, s78, 49152
    s_mul_i32 s87, s74, 196608
    s_add_u32 s87, s87, s76
    s_nop 0
    buffer_load_dwordx4 v5, s[48:51], s87 offen offset:0 lds
    ds_read_b128 v[152:155], v12 offset:4096
    ds_read_b64_tr_b16 v[184:185], v16 offset:24576
    ds_read_b64_tr_b16 v[186:187], v16 offset:24832
    v_mfma_f32_32x32x16_bf16 v[64:79], v[128:131], v[88:91], v[64:79]
    buffer_load_dwordx4 v6, s[48:51], s87 offen offset:1024 lds
    ds_read_b64_tr_b16 v[188:189], v16 offset:25600
    ds_read_b64_tr_b16 v[190:191], v16 offset:25856
    ds_read_b64_tr_b16 v[192:193], v16 offset:26624
    v_mfma_f32_32x32x16_bf16 v[32:47], v[132:135], v[92:95], v[32:47]
    buffer_load_dwordx4 v7, s[48:51], s87 offen offset:2048 lds
    ds_read_b64_tr_b16 v[194:195], v16 offset:26880
    ds_read_b128 v[156:159], v13 offset:4096
    ds_read_b64_tr_b16 v[196:197], v17 offset:24576
    ds_read_b64_tr_b16 v[198:199], v17 offset:24832
    v_mfma_f32_32x32x16_bf16 v[48:63], v[136:139], v[92:95], v[48:63]
    s_add_u32 m0, s79, 36
    s_mov_b64 exec, 1
    global_load_lds_dword v23, s[38:39]
    s_mov_b64 exec, -1
    s_lshr_b64 s[0:1], s[0:1], 4
    s_and_b32 s74, s0, 15
    ds_read_b64_tr_b16 v[200:201], v17 offset:25600
    ds_read_b64_tr_b16 v[202:203], v17 offset:25856
    ds_read_b64_tr_b16 v[204:205], v17 offset:26624
    v_mfma_f32_32x32x16_bf16 v[64:79], v[140:143], v[92:95], v[64:79]
    ds_read_b64_tr_b16 v[206:207], v17 offset:26880
    buffer_load_dword v213, v209, s[44:47], s73 offen sc1
    buffer_load_dwordx4 v[24:27], v208, s[44:47], s83 offen sc1
    s_waitcnt lgkmcnt(15)
    v_mfma_f32_16x16x32_bf16 v[240:243], v[232:235], v[160:163], v[240:243]
    v_mfma_f32_16x16x32_bf16 v[244:247], v[232:235], v[168:171], v[244:247]
    v_mfma_f32_16x16x32_bf16 v[240:243], v[236:239], v[164:167], v[240:243]
    v_mfma_f32_32x32x16_bf16 v[32:47], v[160:163], v[144:147], v[32:47]
    ds_read_b32 v19, v31 offset:96
    v_mfma_f32_32x32x16_bf16 v[48:63], v[164:167], v[144:147], v[48:63]
    v_mfma_f32_32x32x16_bf16 v[64:79], v[168:171], v[144:147], v[64:79]
    s_waitcnt lgkmcnt(0)
    v_cmp_eq_u32 vcc, 0, v19
    s_cbranch_vccnz .rt_19
.rb_20:
    v_mfma_f32_32x32x16_bf16 v[32:47], v[172:175], v[148:151], v[32:47]
    ds_read_b128 v[80:83], v10 offset:8192
    ds_read_b64_tr_b16 v[96:97], v14 offset:36864
    ds_read_b64_tr_b16 v[98:99], v14 offset:37120
    ds_read_b64_tr_b16 v[100:101], v14 offset:37888
    v_mfma_f32_32x32x16_bf16 v[48:63], v[176:179], v[148:151], v[48:63]
    ds_read_b64_tr_b16 v[102:103], v14 offset:38144
    ds_read_b64_tr_b16 v[104:105], v14 offset:38912
    ds_read_b64_tr_b16 v[106:107], v14 offset:39168
    v_mfma_f32_32x32x16_bf16 v[64:79], v[180:183], v[148:151], v[64:79]
    ds_read_b128 v[84:87], v11 offset:8192
    ds_read_b64_tr_b16 v[108:109], v15 offset:36864
    ds_read_b64_tr_b16 v[110:111], v15 offset:37120
    v_mfma_f32_32x32x16_bf16 v[32:47], v[184:187], v[152:155], v[32:47]
    ds_read_b64_tr_b16 v[112:113], v15 offset:37888
    ds_read_b64_tr_b16 v[114:115], v15 offset:38144
    ds_read_b64_tr_b16 v[116:117], v15 offset:38912
    ds_read_b64_tr_b16 v[118:119], v15 offset:39168
    v_mfma_f32_32x32x16_bf16 v[48:63], v[188:191], v[152:155], v[48:63]
    ds_read_b128 v[88:91], v12 offset:8192
    ds_read_b64_tr_b16 v[120:121], v16 offset:36864
    ds_read_b64_tr_b16 v[122:123], v16 offset:37120
    v_mfma_f32_32x32x16_bf16 v[64:79], v[192:195], v[152:155], v[64:79]
    ds_read_b64_tr_b16 v[124:125], v16 offset:37888
    ds_read_b64_tr_b16 v[126:127], v16 offset:38144
    ds_read_b64_tr_b16 v[128:129], v16 offset:38912
    v_mfma_f32_32x32x16_bf16 v[32:47], v[196:199], v[156:159], v[32:47]
    ds_read_b64_tr_b16 v[130:131], v16 offset:39168
    ds_read_b128 v[92:95], v13 offset:8192
    ds_read_b64_tr_b16 v[132:133], v17 offset:36864
    ds_read_b64_tr_b16 v[134:135], v17 offset:37120
    v_mfma_f32_32x32x16_bf16 v[48:63], v[200:203], v[156:159], v[48:63]
    ds_read_b64_tr_b16 v[136:137], v17 offset:37888
    ds_read_b64_tr_b16 v[138:139], v17 offset:38144
    ds_read_b64_tr_b16 v[140:141], v17 offset:38912
    v_mfma_f32_32x32x16_bf16 v[64:79], v[204:207], v[156:159], v[64:79]
    ds_read_b64_tr_b16 v[142:143], v17 offset:39168
    s_waitcnt lgkmcnt(15)
    v_mfma_f32_16x16x32_bf16 v[240:243], v[232:235], v[96:99], v[240:243]
    v_mfma_f32_16x16x32_bf16 v[244:247], v[232:235], v[104:107], v[244:247]
    v_mfma_f32_16x16x32_bf16 v[240:243], v[236:239], v[100:103], v[240:243]
    v_mfma_f32_32x32x16_bf16 v[32:47], v[96:99], v[80:83], v[32:47]
    ds_read_b32 v19, v31 offset:100
    v_mfma_f32_32x32x16_bf16 v[48:63], v[100:103], v[80:83], v[48:63]
    v_mfma_f32_32x32x16_bf16 v[64:79], v[104:107], v[80:83], v[64:79]
    s_waitcnt lgkmcnt(0)
    v_cmp_eq_u32 vcc, 0, v19
    s_cbranch_vccnz .rt_21
.rb_22:
    s_waitcnt vmcnt(1)
    v_cmp_ne_u32 vcc, s67, v213
    s_cbranch_vccnz .rt_23
.rb_24:
    v_mfma_f32_32x32x16_bf16 v[32:47], v[108:111], v[84:87], v[32:47]
    buffer_load_dwordx4 v[96:99], v28, s[44:47], s4 offen offset:0 sc1
    ds_read_b128 v[144:147], v10 offset:0
    ds_read_b64_tr_b16 v[160:161], v14 offset:49152
    ds_read_b64_tr_b16 v[162:163], v14 offset:49408
    ds_read_b64_tr_b16 v[164:165], v14 offset:50176
    v_mfma_f32_32x32x16_bf16 v[48:63], v[112:115], v[84:87], v[48:63]
    buffer_load_dwordx4 v[100:103], v28, s[44:47], s4 offen offset:1024 sc1
    ds_read_b64_tr_b16 v[166:167], v14 offset:50432
    ds_read_b64_tr_b16 v[168:169], v14 offset:51200
    ds_read_b64_tr_b16 v[170:171], v14 offset:51456
    v_mfma_f32_32x32x16_bf16 v[64:79], v[116:119], v[84:87], v[64:79]
    buffer_load_dwordx4 v[104:107], v28, s[44:47], s4 offen offset:2048 sc1
    ds_read_b128 v[148:151], v11 offset:0
    ds_read_b64_tr_b16 v[172:173], v15 offset:49152
    ds_read_b64_tr_b16 v[174:175], v15 offset:49408
    v_mfma_f32_32x32x16_bf16 v[32:47], v[120:123], v[88:91], v[32:47]
    buffer_load_dwordx4 v[108:111], v28, s[44:47], s4 offen offset:3072 sc1
    ds_read_b64_tr_b16 v[176:177], v15 offset:50176
    ds_read_b64_tr_b16 v[178:179], v15 offset:50432
    ds_read_b64_tr_b16 v[180:181], v15 offset:51200
    ds_read_b64_tr_b16 v[182:183], v15 offset:51456
    v_mfma_f32_32x32x16_bf16 v[48:63], v[124:127], v[88:91], v[48:63]
    buffer_load_dwordx4 v[112:115], v29, s[44:47], s4 offen offset:0 sc1
    ds_read_b128 v[152:155], v12 offset:0
    ds_read_b64_tr_b16 v[184:185], v16 offset:49152
    ds_read_b64_tr_b16 v[186:187], v16 offset:49408
    v_mfma_f32_32x32x16_bf16 v[64:79], v[128:131], v[88:91], v[64:79]
    s_add_u32 s13, s4, 5120
    buffer_load_dwordx4 v[116:119], v28, s[44:47], s13 offen offset:0 sc1
    ds_read_b64_tr_b16 v[188:189], v16 offset:50176
    ds_read_b64_tr_b16 v[190:191], v16 offset:50432
    ds_read_b64_tr_b16 v[192:193], v16 offset:51200
    v_mfma_f32_32x32x16_bf16 v[32:47], v[132:135], v[92:95], v[32:47]
    buffer_load_dwordx4 v[120:123], v28, s[44:47], s13 offen offset:1024 sc1
    ds_read_b64_tr_b16 v[194:195], v16 offset:51456
    ds_read_b128 v[156:159], v13 offset:0
    ds_read_b64_tr_b16 v[196:197], v17 offset:49152
    ds_read_b64_tr_b16 v[198:199], v17 offset:49408
    v_mfma_f32_32x32x16_bf16 v[48:63], v[136:139], v[92:95], v[48:63]
    buffer_load_dwordx4 v[124:127], v28, s[44:47], s13 offen offset:2048 sc1
    ds_read_b64_tr_b16 v[200:201], v17 offset:50176
    ds_read_b64_tr_b16 v[202:203], v17 offset:50432
    ds_read_b64_tr_b16 v[204:205], v17 offset:51200
    v_mfma_f32_32x32x16_bf16 v[64:79], v[140:143], v[92:95], v[64:79]
    buffer_load_dwordx4 v[128:131], v28, s[44:47], s13 offen offset:3072 sc1
    ds_read_b64_tr_b16 v[206:207], v17 offset:51456
    s_waitcnt lgkmcnt(15)
    v_mfma_f32_16x16x32_bf16 v[240:243], v[232:235], v[160:163], v[240:243]
    v_mfma_f32_16x16x32_bf16 v[244:247], v[232:235], v[168:171], v[244:247]
    v_mfma_f32_16x16x32_bf16 v[240:243], v[236:239], v[164:167], v[240:243]
    v_mfma_f32_32x32x16_bf16 v[32:47], v[160:163], v[144:147], v[32:47]
    buffer_load_dwordx4 v[132:135], v29, s[44:47], s13 offen offset:0 sc1
    v_mfma_f32_32x32x16_bf16 v[48:63], v[164:167], v[144:147], v[48:63]
    s_add_u32 s13, s4, 10240
    buffer_load_dwordx4 v[136:139], v28, s[44:47], s13 offen offset:0 sc1
    v_mfma_f32_32x32x16_bf16 v[64:79], v[168:171], v[144:147], v[64:79]
    buffer_load_dwordx4 v[140:143], v28, s[44:47], s13 offen offset:1024 sc1
    s_waitcnt vmcnt(12)
    v_cmp_ne_u32 vcc, s67, v27
    s_cbranch_vccnz .rt_25
.rb_26:
    ds_write_b32 v210, v240
    s_mov_b32 exec_hi, 0
    ds_write_b32 v210, v244 offset:1024
    s_mov_b32 exec_hi, -1
    v_mov_b32 v18, 11
    ds_write_b32 v8, v18
    s_waitcnt lgkmcnt(15)
    v_mfma_f32_32x32x16_bf16 v[32:47], v[172:175], v[148:151], v[32:47]
    buffer_load_dwordx4 v[144:147], v28, s[44:47], s13 offen offset:2048 sc1
    v_mfma_f32_32x32x16_bf16 v[48:63], v[176:179], v[148:151], v[48:63]
    buffer_load_dwordx4 v[160:163], v28, s[44:47], s5 offen offset:1024 sc1
    v_mfma_f32_32x32x16_bf16 v[64:79], v[180:183], v[148:151], v[64:79]
    ds_read_b32 v19, v9
    s_waitcnt lgkmcnt(11)
    v_mfma_f32_32x32x16_bf16 v[32:47], v[184:187], v[152:155], v[32:47]
    v_mfma_f32_32x32x16_bf16 v[48:63], v[188:191], v[152:155], v[48:63]
    v_mfma_f32_32x32x16_bf16 v[64:79], v[192:195], v[152:155], v[64:79]
    s_waitcnt lgkmcnt(0)
    v_cmp_gt_u32 vcc, 11, v19
    s_cbranch_vccnz .br_27
.bb_28:
    ds_read_b128 v[220:223], v211 offset:0
    ds_read_b128 v[224:227], v211 offset:512
    ds_read_b128 v[228:231], v211 offset:1024
    v_mfma_f32_32x32x16_bf16 v[32:47], v[196:199], v[156:159], v[32:47]
    v_mfma_f32_32x32x16_bf16 v[48:63], v[200:203], v[156:159], v[48:63]
    v_mfma_f32_32x32x16_bf16 v[64:79], v[204:207], v[156:159], v[64:79]
    s_mov_b32 vcc_lo, 0
    s_mov_b32 vcc_hi, -1
    v_cndmask_b32 v25, v25, v26, vcc
    s_waitcnt lgkmcnt(2)
    v_add_f32 v220, v220, v221
    v_add_f32 v222, v222, v223
    v_lshlrev_b32 v216, 16, v216
    v_add_f32 v220, v220, v222
    v_cndmask_b32 v220, v220, v216, vcc
    s_waitcnt lgkmcnt(1)
    v_add_f32 v224, v224, v225
    v_add_f32 v226, v226, v227
    v_lshlrev_b32 v217, 16, v217
    v_add_f32 v224, v224, v226
    v_cndmask_b32 v224, v224, v217, vcc
    s_waitcnt lgkmcnt(0)
    v_add_f32 v228, v228, v229
    v_add_f32 v230, v230, v231
    v_lshlrev_b32 v218, 16, v218
    v_add_f32_e64 v228, v228, v230
    v_cndmask_b32 v228, v228, v218, vcc
    v_mfma_f32_32x32x2_f32 v[32:47], v220, v25, v[32:47]
    v_mfma_f32_32x32x2_f32 v[48:63], v224, v25, v[48:63]
    v_mfma_f32_32x32x2_f32 v[64:79], v228, v25, v[64:79]
    v_mul_f32 v20, v24, v24
    v_mul_f32 v21, s85, v24
    v_mul_f32 v20, v20, v24
    v_mul_f32_e64 v20, s84, v20
    s_nop 11
    v_pk_mul_f32 v[80:81], v[32:33], v[32:33]
    v_pk_mul_f32 v[82:83], v[34:35], v[34:35]
    v_pk_mul_f32 v[84:85], v[36:37], v[36:37]
    v_pk_mul_f32 v[86:87], v[38:39], v[38:39]
    v_pk_mul_f32 v[88:89], v[40:41], v[40:41]
    v_pk_mul_f32 v[90:91], v[42:43], v[42:43]
    v_pk_mul_f32 v[92:93], v[44:45], v[44:45]
    v_pk_mul_f32 v[94:95], v[46:47], v[46:47]
    v_pk_fma_f32 v[80:81], v[80:81], v[20:21], v[20:21] op_sel:[0,0,1] op_sel_hi:[1,0,1]
    v_pk_fma_f32 v[82:83], v[82:83], v[20:21], v[20:21] op_sel:[0,0,1] op_sel_hi:[1,0,1]
    v_pk_fma_f32 v[84:85], v[84:85], v[20:21], v[20:21] op_sel:[0,0,1] op_sel_hi:[1,0,1]
    v_pk_fma_f32 v[86:87], v[86:87], v[20:21], v[20:21] op_sel:[0,0,1] op_sel_hi:[1,0,1]
    v_pk_fma_f32 v[88:89], v[88:89], v[20:21], v[20:21] op_sel:[0,0,1] op_sel_hi:[1,0,1]
    v_pk_fma_f32 v[90:91], v[90:91], v[20:21], v[20:21] op_sel:[0,0,1] op_sel_hi:[1,0,1]
    v_pk_fma_f32 v[92:93], v[92:93], v[20:21], v[20:21] op_sel:[0,0,1] op_sel_hi:[1,0,1]
    v_pk_fma_f32 v[94:95], v[94:95], v[20:21], v[20:21] op_sel:[0,0,1] op_sel_hi:[1,0,1]
    v_pk_mul_f32 v[80:81], v[80:81], v[32:33]
    v_pk_mul_f32 v[82:83], v[82:83], v[34:35]
    v_pk_mul_f32 v[84:85], v[84:85], v[36:37]
    v_pk_mul_f32 v[86:87], v[86:87], v[38:39]
    v_pk_mul_f32 v[88:89], v[88:89], v[40:41]
    v_pk_mul_f32 v[90:91], v[90:91], v[42:43]
    v_pk_mul_f32 v[92:93], v[92:93], v[44:45]
    v_pk_mul_f32 v[94:95], v[94:95], v[46:47]
    buffer_load_dwordx4 v[148:151], v28, s[44:47], s13 offen offset:3072 sc1
    v_exp_f32 v80, v80
    v_exp_f32 v81, v81
    v_exp_f32 v82, v82
    v_exp_f32 v83, v83
    v_exp_f32 v84, v84
    v_exp_f32 v85, v85
    v_exp_f32 v86, v86
    v_exp_f32 v87, v87
    v_exp_f32 v88, v88
    v_exp_f32 v89, v89
    v_exp_f32 v90, v90
    v_exp_f32 v91, v91
    v_exp_f32 v92, v92
    v_exp_f32 v93, v93
    v_exp_f32 v94, v94
    v_exp_f32 v95, v95
    v_pk_fma_f32 v[80:81], v[80:81], v[26:27], v[26:27] op_sel_hi:[1,0,0]
    v_pk_fma_f32 v[82:83], v[82:83], v[26:27], v[26:27] op_sel_hi:[1,0,0]
    v_pk_fma_f32 v[84:85], v[84:85], v[26:27], v[26:27] op_sel_hi:[1,0,0]
    v_pk_fma_f32 v[86:87], v[86:87], v[26:27], v[26:27] op_sel_hi:[1,0,0]
    v_pk_fma_f32 v[88:89], v[88:89], v[26:27], v[26:27] op_sel_hi:[1,0,0]
    v_pk_fma_f32 v[90:91], v[90:91], v[26:27], v[26:27] op_sel_hi:[1,0,0]
    v_pk_fma_f32 v[92:93], v[92:93], v[26:27], v[26:27] op_sel_hi:[1,0,0]
    v_pk_fma_f32 v[94:95], v[94:95], v[26:27], v[26:27] op_sel_hi:[1,0,0]
    v_rcp_f32 v80, v80
    v_rcp_f32 v81, v81
    v_rcp_f32 v82, v82
    v_rcp_f32 v83, v83
    v_rcp_f32 v84, v84
    v_rcp_f32 v85, v85
    v_rcp_f32 v86, v86
    v_rcp_f32 v87, v87
    v_pk_mul_f32 v[80:81], v[32:33], v[80:81]
    v_pk_mul_f32 v[82:83], v[34:35], v[82:83]
    v_pk_mul_f32 v[84:85], v[36:37], v[84:85]
    v_pk_mul_f32 v[86:87], v[38:39], v[86:87]
    v_cvt_pk_bf16_f32 v32, v80, v81
    v_cvt_pk_bf16_f32 v33, v82, v83
    v_cvt_pk_bf16_f32 v34, v84, v85
    v_cvt_pk_bf16_f32 v35, v86, v87
    buffer_store_dwordx4 v[32:35], v212, s[44:47], s80 offen offset:0 sc1
    v_rcp_f32 v88, v88
    v_rcp_f32 v89, v89
    v_rcp_f32 v90, v90
    v_rcp_f32 v91, v91
    v_rcp_f32 v92, v92
    v_rcp_f32 v93, v93
    v_rcp_f32 v94, v94
    v_rcp_f32 v95, v95
    v_pk_mul_f32 v[88:89], v[40:41], v[88:89]
    v_pk_mul_f32 v[90:91], v[42:43], v[90:91]
    v_pk_mul_f32 v[92:93], v[44:45], v[92:93]
    v_pk_mul_f32 v[94:95], v[46:47], v[94:95]
    v_cvt_pk_bf16_f32 v40, v88, v89
    v_cvt_pk_bf16_f32 v41, v90, v91
    v_cvt_pk_bf16_f32 v42, v92, v93
    v_cvt_pk_bf16_f32 v43, v94, v95
    buffer_store_dwordx4 v[40:43], v212, s[44:47], s80 offen offset:512 sc1
    s_add_u32 s80, s80, 4096
    v_pk_mul_f32 v[224:225], v[48:49], v[48:49]
    v_pk_mul_f32 v[226:227], v[50:51], v[50:51]
    v_pk_mul_f32 v[228:229], v[52:53], v[52:53]
    v_pk_mul_f32 v[230:231], v[54:55], v[54:55]
    v_pk_mul_f32 v[232:233], v[56:57], v[56:57]
    v_pk_mul_f32 v[234:235], v[58:59], v[58:59]
    v_pk_mul_f32 v[236:237], v[60:61], v[60:61]
    v_pk_mul_f32 v[238:239], v[62:63], v[62:63]
    v_pk_fma_f32 v[224:225], v[224:225], v[20:21], v[20:21] op_sel:[0,0,1] op_sel_hi:[1,0,1]
    v_pk_fma_f32 v[226:227], v[226:227], v[20:21], v[20:21] op_sel:[0,0,1] op_sel_hi:[1,0,1]
    v_pk_fma_f32 v[228:229], v[228:229], v[20:21], v[20:21] op_sel:[0,0,1] op_sel_hi:[1,0,1]
    v_pk_fma_f32 v[230:231], v[230:231], v[20:21], v[20:21] op_sel:[0,0,1] op_sel_hi:[1,0,1]
    v_pk_fma_f32 v[232:233], v[232:233], v[20:21], v[20:21] op_sel:[0,0,1] op_sel_hi:[1,0,1]
    v_pk_fma_f32 v[234:235], v[234:235], v[20:21], v[20:21] op_sel:[0,0,1] op_sel_hi:[1,0,1]
    v_pk_fma_f32 v[236:237], v[236:237], v[20:21], v[20:21] op_sel:[0,0,1] op_sel_hi:[1,0,1]
    v_pk_fma_f32 v[238:239], v[238:239], v[20:21], v[20:21] op_sel:[0,0,1] op_sel_hi:[1,0,1]
    v_pk_mul_f32 v[224:225], v[224:225], v[48:49]
    v_pk_mul_f32 v[226:227], v[226:227], v[50:51]
    v_pk_mul_f32 v[228:229], v[228:229], v[52:53]
    v_pk_mul_f32 v[230:231], v[230:231], v[54:55]
    v_pk_mul_f32 v[232:233], v[232:233], v[56:57]
    v_pk_mul_f32 v[234:235], v[234:235], v[58:59]
    v_pk_mul_f32 v[236:237], v[236:237], v[60:61]
    v_pk_mul_f32 v[238:239], v[238:239], v[62:63]
    buffer_load_dwordx4 v[152:155], v29, s[44:47], s13 offen offset:0 sc1
    v_exp_f32 v224, v224
    v_exp_f32 v225, v225
    v_exp_f32 v226, v226
    v_exp_f32 v227, v227
    v_exp_f32 v228, v228
    v_exp_f32 v229, v229
    v_exp_f32 v230, v230
    v_exp_f32 v231, v231
    v_exp_f32 v232, v232
    v_exp_f32 v233, v233
    v_exp_f32 v234, v234
    v_exp_f32 v235, v235
    v_exp_f32 v236, v236
    v_exp_f32 v237, v237
    v_exp_f32 v238, v238
    v_exp_f32 v239, v239
    v_pk_fma_f32 v[224:225], v[224:225], v[26:27], v[26:27] op_sel_hi:[1,0,0]
    v_pk_fma_f32 v[226:227], v[226:227], v[26:27], v[26:27] op_sel_hi:[1,0,0]
    v_pk_fma_f32 v[228:229], v[228:229], v[26:27], v[26:27] op_sel_hi:[1,0,0]
    v_pk_fma_f32 v[230:231], v[230:231], v[26:27], v[26:27] op_sel_hi:[1,0,0]
    v_pk_fma_f32 v[232:233], v[232:233], v[26:27], v[26:27] op_sel_hi:[1,0,0]
    v_pk_fma_f32 v[234:235], v[234:235], v[26:27], v[26:27] op_sel_hi:[1,0,0]
    v_pk_fma_f32 v[236:237], v[236:237], v[26:27], v[26:27] op_sel_hi:[1,0,0]
    v_pk_fma_f32 v[238:239], v[238:239], v[26:27], v[26:27] op_sel_hi:[1,0,0]
    v_rcp_f32 v224, v224
    v_rcp_f32 v225, v225
    v_rcp_f32 v226, v226
    v_rcp_f32 v227, v227
    v_rcp_f32 v228, v228
    v_rcp_f32 v229, v229
    v_rcp_f32 v230, v230
    v_rcp_f32 v231, v231
    v_pk_mul_f32 v[224:225], v[48:49], v[224:225]
    v_pk_mul_f32 v[226:227], v[50:51], v[226:227]
    v_pk_mul_f32 v[228:229], v[52:53], v[228:229]
    v_pk_mul_f32 v[230:231], v[54:55], v[230:231]
    v_cvt_pk_bf16_f32 v48, v224, v225
    v_cvt_pk_bf16_f32 v49, v226, v227
    v_cvt_pk_bf16_f32 v50, v228, v229
    v_cvt_pk_bf16_f32 v51, v230, v231
    buffer_store_dwordx4 v[48:51], v212, s[44:47], s80 offen offset:0 sc1
    v_rcp_f32 v232, v232
    v_rcp_f32 v233, v233
    v_rcp_f32 v234, v234
    v_rcp_f32 v235, v235
    v_rcp_f32 v236, v236
    v_rcp_f32 v237, v237
    v_rcp_f32 v238, v238
    v_rcp_f32 v239, v239
    v_pk_mul_f32 v[232:233], v[56:57], v[232:233]
    v_pk_mul_f32 v[234:235], v[58:59], v[234:235]
    v_pk_mul_f32 v[236:237], v[60:61], v[236:237]
    v_pk_mul_f32 v[238:239], v[62:63], v[238:239]
    v_cvt_pk_bf16_f32 v56, v232, v233
    v_cvt_pk_bf16_f32 v57, v234, v235
    v_cvt_pk_bf16_f32 v58, v236, v237
    v_cvt_pk_bf16_f32 v59, v238, v239
    buffer_store_dwordx4 v[56:59], v212, s[44:47], s80 offen offset:512 sc1
    s_add_u32 s80, s80, 4096
    v_pk_mul_f32 v[240:241], v[64:65], v[64:65]
    v_pk_mul_f32 v[242:243], v[66:67], v[66:67]
    v_pk_mul_f32 v[244:245], v[68:69], v[68:69]
    v_pk_mul_f32 v[246:247], v[70:71], v[70:71]
    v_pk_mul_f32 v[248:249], v[72:73], v[72:73]
    v_pk_mul_f32 v[250:251], v[74:75], v[74:75]
    v_pk_mul_f32 v[252:253], v[76:77], v[76:77]
    v_pk_mul_f32 v[254:255], v[78:79], v[78:79]
    v_pk_fma_f32 v[240:241], v[240:241], v[20:21], v[20:21] op_sel:[0,0,1] op_sel_hi:[1,0,1]
    v_pk_fma_f32 v[242:243], v[242:243], v[20:21], v[20:21] op_sel:[0,0,1] op_sel_hi:[1,0,1]
    v_pk_fma_f32 v[244:245], v[244:245], v[20:21], v[20:21] op_sel:[0,0,1] op_sel_hi:[1,0,1]
    v_pk_fma_f32 v[246:247], v[246:247], v[20:21], v[20:21] op_sel:[0,0,1] op_sel_hi:[1,0,1]
    v_pk_fma_f32 v[248:249], v[248:249], v[20:21], v[20:21] op_sel:[0,0,1] op_sel_hi:[1,0,1]
    v_pk_fma_f32 v[250:251], v[250:251], v[20:21], v[20:21] op_sel:[0,0,1] op_sel_hi:[1,0,1]
    v_pk_fma_f32 v[252:253], v[252:253], v[20:21], v[20:21] op_sel:[0,0,1] op_sel_hi:[1,0,1]
    v_pk_fma_f32 v[254:255], v[254:255], v[20:21], v[20:21] op_sel:[0,0,1] op_sel_hi:[1,0,1]
    v_pk_mul_f32 v[240:241], v[240:241], v[64:65]
    v_pk_mul_f32 v[242:243], v[242:243], v[66:67]
    v_pk_mul_f32 v[244:245], v[244:245], v[68:69]
    v_pk_mul_f32 v[246:247], v[246:247], v[70:71]
    v_pk_mul_f32 v[248:249], v[248:249], v[72:73]
    v_pk_mul_f32 v[250:251], v[250:251], v[74:75]
    v_pk_mul_f32 v[252:253], v[252:253], v[76:77]
    v_pk_mul_f32 v[254:255], v[254:255], v[78:79]
    buffer_load_dwordx4 v[156:159], v28, s[44:47], s5 offen offset:0 sc1
    v_exp_f32 v240, v240
    v_exp_f32 v241, v241
    v_exp_f32 v242, v242
    v_exp_f32 v243, v243
    v_exp_f32 v244, v244
    v_exp_f32 v245, v245
    v_exp_f32 v246, v246
    v_exp_f32 v247, v247
    v_exp_f32 v248, v248
    v_exp_f32 v249, v249
    v_exp_f32 v250, v250
    v_exp_f32 v251, v251
    v_exp_f32 v252, v252
    v_exp_f32 v253, v253
    v_exp_f32 v254, v254
    v_exp_f32 v255, v255
    v_pk_fma_f32 v[240:241], v[240:241], v[26:27], v[26:27] op_sel_hi:[1,0,0]
    v_pk_fma_f32 v[242:243], v[242:243], v[26:27], v[26:27] op_sel_hi:[1,0,0]
    v_pk_fma_f32 v[244:245], v[244:245], v[26:27], v[26:27] op_sel_hi:[1,0,0]
    v_pk_fma_f32 v[246:247], v[246:247], v[26:27], v[26:27] op_sel_hi:[1,0,0]
    v_pk_fma_f32 v[248:249], v[248:249], v[26:27], v[26:27] op_sel_hi:[1,0,0]
    v_pk_fma_f32 v[250:251], v[250:251], v[26:27], v[26:27] op_sel_hi:[1,0,0]
    v_pk_fma_f32 v[252:253], v[252:253], v[26:27], v[26:27] op_sel_hi:[1,0,0]
    v_pk_fma_f32 v[254:255], v[254:255], v[26:27], v[26:27] op_sel_hi:[1,0,0]
    v_rcp_f32 v240, v240
    v_rcp_f32 v241, v241
    v_rcp_f32 v242, v242
    v_rcp_f32 v243, v243
    v_rcp_f32 v244, v244
    v_rcp_f32 v245, v245
    v_rcp_f32 v246, v246
    v_rcp_f32 v247, v247
    v_pk_mul_f32 v[240:241], v[64:65], v[240:241]
    v_pk_mul_f32 v[242:243], v[66:67], v[242:243]
    v_pk_mul_f32 v[244:245], v[68:69], v[244:245]
    v_pk_mul_f32 v[246:247], v[70:71], v[246:247]
    v_cvt_pk_bf16_f32 v64, v240, v241
    v_cvt_pk_bf16_f32 v65, v242, v243
    v_cvt_pk_bf16_f32 v66, v244, v245
    v_cvt_pk_bf16_f32 v67, v246, v247
    buffer_store_dwordx4 v[64:67], v212, s[44:47], s80 offen offset:0 sc1
    v_rcp_f32 v248, v248
    v_rcp_f32 v249, v249
    v_rcp_f32 v250, v250
    v_rcp_f32 v251, v251
    v_rcp_f32 v252, v252
    v_rcp_f32 v253, v253
    v_rcp_f32 v254, v254
    v_rcp_f32 v255, v255
    v_pk_mul_f32 v[248:249], v[72:73], v[248:249]
    v_pk_mul_f32 v[250:251], v[74:75], v[250:251]
    v_pk_mul_f32 v[252:253], v[76:77], v[252:253]
    v_pk_mul_f32 v[254:255], v[78:79], v[254:255]
    v_mov_b32_e64 v18, 12
    ds_write_b32 v8, v18
    v_cvt_pk_bf16_f32 v72, v248, v249
    v_cvt_pk_bf16_f32 v73, v250, v251
    v_cvt_pk_bf16_f32 v74, v252, v253
    v_cvt_pk_bf16_f32 v75, v254, v255
    buffer_store_dwordx4 v[72:75], v212, s[44:47], s80 offen offset:512 sc1
    buffer_load_dwordx4 v[164:167], v28, s[44:47], s5 offen offset:2048 sc1
    buffer_load_dwordx4 v[168:171], v28, s[44:47], s5 offen offset:3072 sc1
    buffer_load_dwordx4 v[172:175], v29, s[44:47], s5 offen offset:0 sc1
    s_add_u32 s13, s5, 5120
    buffer_load_dwordx4 v[176:179], v28, s[44:47], s13 offen offset:0 sc1
    buffer_load_dwordx4 v[180:183], v28, s[44:47], s13 offen offset:1024 sc1
    buffer_load_dwordx4 v[184:187], v28, s[44:47], s13 offen offset:2048 sc1
    s_lshl_b32 s81, s86, 2
    s_and_b32 s70, s63, 3
    s_add_u32 s81, s81, s70
    s_lshl_b32 s81, s81, 7
    s_lshr_b32 s70, s63, 2
    s_lshl_b32 s70, s70, 1
    s_and_b32 s12, s72, 1
    s_add_u32 s70, s70, s12
    s_lshl_b32 s70, s70, 2
    s_add_u32 s81, s81, s70
    s_add_u32 s81, s81, 65536
    s_mul_i32 s18, s72, 11264
    s_add_u32 s18, s18, 118784
    s_mul_i32 s19, s72, 3072
    s_add_u32 s19, s19, 40960
    s_mul_i32 s12, s64, 196608
    s_mul_i32 s70, s72, 12288
    s_add_u32 s12, s12, s70
    s_add_u32 s12, s12, 6291456
    s_xor_b32 s70, s82, 0
    s_mul_i32 s70, s70, 49152
    s_add_u32 s8, s12, s70
    s_xor_b32 s70, s82, 1
    s_mul_i32 s70, s70, 49152
    s_add_u32 s9, s12, s70
    s_xor_b32 s70, s82, 2
    s_mul_i32 s70, s70, 49152
    s_add_u32 s10, s12, s70
    s_xor_b32 s70, s82, 3
    s_mul_i32 s70, s70, 49152
    s_add_u32 s11, s12, s70
    s_lshl_b32 s17, s72, 12
    s_add_u32 s17, s17, 102400
    s_mov_b64 s[56:57], s[32:33]
    s_mov_b32 s58, 2621440
    s_mov_b32 s59, 0x20000
    s_mov_b32 s15, s72
    s_mul_i32 s72, s61, 86
    s_lshr_b32 s72, s72, 8
    s_mul_i32 s73, s72, 3
    s_sub_u32 s73, s61, s73
    s_mul_i32 s69, s60, 80
    s_sub_u32 s69, s69, s72
    s_mul_i32 s72, s61, 3
    s_add_u32 s69, s69, s72
    s_cmp_eq_u32 s73, 2
    s_cselect_b32 s68, 2, 3
    s_cmp_ge_u32 s61, 30
    s_cselect_b32 s68, 0, s68
    s_mov_b32 s72, s15
    v_mov_b32 v18, s67
    s_waitcnt vmcnt(6)
    s_mov_b64 exec, 1
    buffer_store_dword v18, off, s[44:47], s81 sc1
    s_mov_b64 exec, -1
    buffer_load_dwordx4 v[188:191], v28, s[44:47], s13 offen offset:3072 sc1
    v_and_b32 v2, 15, v0
    v_bfe_u32 v3, v0, 4, 1
    v_lshrrev_b32_e64 v13, 5, v0
    v_lshl_add_u32 v13, v3, 8, v13
    buffer_load_dwordx4 v[192:195], v29, s[44:47], s13 offen offset:0 sc1
    v_mul_u32_u24 v13, 1280, v13
    v_lshl_add_u32 v13, v2, 3, v13
    s_lshr_b32 s73, s64, 3
    s_lshl_b32 s73, s73, 9
    s_add_u32 s13, s5, 10240
    buffer_load_dwordx4 v[196:199], v28, s[44:47], s13 offen offset:0 sc1
    s_and_b32 s16, s64, 6
    s_lshl_b32 s16, s16, 5
    s_add_u32 s73, s73, s16
    s_and_b32 s16, s64, 1
    buffer_load_dwordx4 v[200:203], v28, s[44:47], s13 offen offset:1024 sc1
    s_lshl_b32 s16, s16, 3
    s_add_u32 s73, s73, s16
    s_lshl_b32 s16, s72, 1
    s_add_u32 s73, s73, s16
    buffer_load_dwordx4 v[204:207], v28, s[44:47], s13 offen offset:2048 sc1
    s_mul_i32 s73, s73, 1280
    s_lshl_b32 s75, s65, 7
    s_lshr_b32 s16, s65, 2
    s_lshl_b32 s16, s16, 7
    v_mov_b32 v20, 452
    s_mov_b32 s71, 0x200000
.ug_29:
    ds_read_b32 v19, v20
    s_waitcnt lgkmcnt(0)
    v_readfirstlane_b32 s70, v19
    s_nop 0
    s_cmp_lg_u32 s70, 0
    s_cbranch_scc1 .uge_30
    s_sleep 1
    s_sub_u32 s71, s71, 1
    s_cbranch_scc0 .ug_29
.uge_30:
    s_add_u32 m0, s77, 4096
    s_nop 0
    buffer_load_dwordx4 v28, s[44:47], s6 offen offset:0 sc1 lds
    s_and_b32 s12, s65, 3
    s_lshl_b32 s12, s12, 1
    s_add_u32 s76, s16, s12
    s_add_u32 s76, s76, 1024
    buffer_load_dwordx4 v28, s[44:47], s6 offen offset:1024 sc1 lds
    s_add_u32 s16, s73, 0
    s_add_u32 s20, s16, s75
    s_add_u32 s24, s16, s76
    s_add_u32 s16, s73, 20480
    buffer_load_dwordx4 v28, s[44:47], s6 offen offset:2048 sc1 lds
    s_add_u32 s21, s16, s75
    s_add_u32 s25, s16, s76
    s_add_u32 s16, s73, 40960
    s_add_u32 s22, s16, s75
    buffer_load_dwordx4 v28, s[44:47], s6 offen offset:3072 sc1 lds
    s_add_u32 s26, s16, s76
    s_add_u32 s16, s73, 61440
    s_add_u32 s23, s16, s75
    s_add_u32 s27, s16, s76
    s_add_u32 m0, s77, 8192
    s_nop 0
    buffer_load_dwordx4 v29, s[44:47], s6 offen offset:0 sc1 lds
    s_add_u32 s87, s73, s75
    s_add_u32 s78, s73, s76
    s_add_u32 s30, s30, s75
    s_addc_u32 s31, s31, 0
    s_sub_u32 s76, s76, s75
    v_lshlrev_b32_e64 v15, 3, v2
    s_add_u32 m0, s77, 9216
    s_add_u32 s13, s6, 5120
    buffer_load_dwordx4 v28, s[44:47], s13 offen offset:0 sc1 lds
    s_sub_u32 s16, s72, 1
    s_and_b32 s16, s16, 3
    s_mul_i32 s16, s16, 12288
    s_add_u32 s84, s16, 53248
    buffer_load_dwordx4 v28, s[44:47], s13 offen offset:1024 sc1 lds
    s_sub_u32 s16, s72, 2
    s_and_b32 s16, s16, 3
    s_mul_i32 s16, s16, 12288
    s_add_u32 s85, s16, 58368
    buffer_load_dwordx4 v28, s[44:47], s13 offen offset:2048 sc1 lds
    s_sub_u32 s16, s72, 3
    s_and_b32 s16, s16, 3
    s_mul_i32 s16, s16, 11264
    s_add_u32 s86, s16, 118784
    s_add_u32 m0, s77, -3072
    s_nop 0
    buffer_load_dwordx4 v28, s[44:47], s13 offen offset:3072 sc1 lds
    s_lshl_b32 s16, s72, 5
    s_add_u32 s83, s16, 512
    s_movk_i32 s82, 528
    s_cmp_gt_u32 s72, s68
    s_cselect_b32 s73, 0, s72
    s_min_u32 s75, s73, 1
    s_add_u32 m0, s77, 1024
    s_nop 0
    buffer_load_dwordx4 v29, s[44:47], s13 offen offset:0 sc1 lds
    s_lshl_b32 s73, s73, 2
    s_add_u32 s73, s73, 460
    s_add_u32 m0, s77, 2048
    s_add_u32 s13, s6, 10240
    buffer_load_dwordx4 v28, s[44:47], s13 offen offset:0 sc1 lds
    buffer_load_dwordx4 v28, s[44:47], s13 offen offset:1024 sc1 lds
    ds_read_b32 v19, v9
    s_waitcnt lgkmcnt(0)
    v_cmp_gt_u32 vcc, 12, v19
    s_cbranch_vccnz .br_31
.bb_32:
    s_add_u32 m0, s18, -3072
    s_add_u32 s13, s5, 10240
    buffer_load_dwordx4 v28, s[44:47], s13 offen offset:3072 sc1 lds
    s_add_u32 m0, s18, 1024
    s_nop 0
    buffer_load_dwordx4 v29, s[44:47], s13 offen offset:0 sc1 lds
    s_add_u32 m0, s18, 0
    s_add_u32 s13, s6, 10240
    buffer_load_dwordx4 v28, s[44:47], s13 offen offset:2048 sc1 lds
    buffer_load_dwordx4 v28, s[44:47], s13 offen offset:3072 sc1 lds
    s_add_u32 m0, s18, 4096
    s_nop 0
    buffer_load_dwordx4 v29, s[44:47], s13 offen offset:0 sc1 lds
    s_add_u32 m0, s18, 5120
    s_nop 0
    buffer_load_dwordx4 v28, s[44:47], s7 offen offset:0 sc1 lds
    buffer_load_dwordx4 v28, s[44:47], s7 offen offset:1024 sc1 lds
    buffer_load_dwordx4 v28, s[44:47], s7 offen offset:2048 sc1 lds
    s_lshl_b32 s74, s64, 2
    s_add_u32 s74, s74, s72
    s_lshl_b32 s74, s74, 7
    s_add_u32 s74, s74, 65536
    s_buffer_load_dwordx8 s[48:55], s[44:47], s74 glc
    buffer_load_dwordx4 v28, s[44:47], s7 offen offset:3072 sc1 lds
    s_add_u32 m0, s18, 9216
    s_nop 0
    buffer_load_dwordx4 v29, s[44:47], s7 offen offset:0 sc1 lds
    s_add_u32 m0, s18, 10240
    s_add_u32 s13, s7, 5120
    buffer_load_dwordx4 v28, s[44:47], s13 offen offset:0 sc1 lds
    s_add_u32 m0, s19, -1024
    s_nop 0
    buffer_load_dwordx4 v28, s[44:47], s13 offen offset:1024 sc1 lds
    buffer_load_dwordx4 v28, s[44:47], s13 offen offset:2048 sc1 lds
    buffer_load_dwordx4 v28, s[44:47], s13 offen offset:3072 sc1 lds
    s_add_u32 s70, s72, 0
    s_and_b32 s70, s70, 3
    s_lshl_b32 s70, s70, 10
    v_add_u32 v4, s70, v28
    s_add_u32 s70, s72, 1
    s_and_b32 s70, s70, 3
    s_lshl_b32 s70, s70, 10
    v_add_u32 v5, s70, v28
    s_add_u32 s70, s72, 2
    s_and_b32 s70, s70, 3
    s_lshl_b32 s70, s70, 10
    v_add_u32 v6, s70, v28
    s_add_u32 s70, s72, 3
    s_and_b32 s70, s70, 3
    s_lshl_b32 s70, s70, 10
    v_add_u32 v7, s70, v28
    v_add_u32 v10, s77, v28
    v_add_u32 v11, s18, v28
    v_add_u32 v12, s19, v28
    v_mov_b32 v1, v28
    v_mov_b32 v14, v29
    s_mov_b32 s14, s67
    s_mov_b32 s15, s67
    s_waitcnt lgkmcnt(0)
    s_xor_b64 s[48:49], s[48:49], s[14:15]
    s_xor_b64 s[50:51], s[50:51], s[14:15]
    s_xor_b64 s[52:53], s[52:53], s[14:15]
    s_xor_b64 s[54:55], s[54:55], s[14:15]
    s_or_b64 s[48:49], s[48:49], s[50:51]
    s_or_b64 s[52:53], s[52:53], s[54:55]
    s_or_b64 vcc, s[48:49], s[52:53]
    s_cbranch_vccnz .rt_33
.rb_34:
    buffer_load_dwordx4 v[208:211], v4, s[44:47], s8 offen sc1
    buffer_load_dwordx4 v[212:215], v5, s[44:47], s8 offen sc1
    buffer_load_dwordx4 v[216:219], v6, s[44:47], s8 offen sc1
    buffer_load_dwordx4 v[220:223], v7, s[44:47], s8 offen sc1
    s_add_u32 s12, s8, 4096
    buffer_load_dwordx4 v[224:227], v4, s[44:47], s12 offen sc1
    buffer_load_dwordx4 v[228:231], v5, s[44:47], s12 offen sc1
    buffer_load_dwordx4 v[232:235], v6, s[44:47], s12 offen sc1
    buffer_load_dwordx4 v[236:239], v7, s[44:47], s12 offen sc1
    s_add_u32 s12, s8, 8192
    buffer_load_dwordx4 v[240:243], v4, s[44:47], s12 offen sc1
    buffer_load_dwordx4 v[244:247], v5, s[44:47], s12 offen sc1
    buffer_load_dwordx4 v[248:251], v6, s[44:47], s12 offen sc1
    buffer_load_dwordx4 v[252:255], v7, s[44:47], s12 offen sc1
    s_waitcnt vmcnt(11)
    v_mfma_f32_16x16x32_bf16 v[16:19], v[208:211], v[96:99], 0
    s_waitcnt vmcnt(10)
    v_mfma_f32_16x16x32_bf16 v[36:39], v[212:215], v[96:99], 0
    s_waitcnt vmcnt(9)
    v_mfma_f32_16x16x32_bf16 v[56:59], v[216:219], v[96:99], 0
    s_waitcnt vmcnt(8)
    v_mfma_f32_16x16x32_bf16 v[76:79], v[220:223], v[96:99], 0
    v_mfma_f32_16x16x32_bf16 v[20:23], v[208:211], v[100:103], 0
    v_mfma_f32_16x16x32_bf16 v[40:43], v[212:215], v[100:103], 0
    v_mfma_f32_16x16x32_bf16 v[60:63], v[216:219], v[100:103], 0
    v_mfma_f32_16x16x32_bf16 v[80:83], v[220:223], v[100:103], 0
    v_mfma_f32_16x16x32_bf16 v[24:27], v[208:211], v[104:107], 0
    v_mfma_f32_16x16x32_bf16 v[44:47], v[212:215], v[104:107], 0
    buffer_load_dwordx4 v[96:99], v4, s[44:47], s9 offen sc1
    v_mfma_f32_16x16x32_bf16 v[64:67], v[216:219], v[104:107], 0
    v_mfma_f32_16x16x32_bf16 v[84:87], v[220:223], v[104:107], 0
    v_mfma_f32_16x16x32_bf16 v[28:31], v[208:211], v[108:111], 0
    v_mfma_f32_16x16x32_bf16 v[48:51], v[212:215], v[108:111], 0
    buffer_load_dwordx4 v[100:103], v5, s[44:47], s9 offen sc1
    v_mfma_f32_16x16x32_bf16 v[68:71], v[216:219], v[108:111], 0
    v_mfma_f32_16x16x32_bf16 v[88:91], v[220:223], v[108:111], 0
    v_mfma_f32_16x16x32_bf16 v[32:35], v[208:211], v[112:115], 0
    v_mfma_f32_16x16x32_bf16 v[52:55], v[212:215], v[112:115], 0
    buffer_load_dwordx4 v[104:107], v6, s[44:47], s9 offen sc1
    v_mfma_f32_16x16x32_bf16 v[72:75], v[216:219], v[112:115], 0
    v_mfma_f32_16x16x32_bf16 v[92:95], v[220:223], v[112:115], 0
    buffer_load_dwordx4 v[108:111], v7, s[44:47], s9 offen sc1
    s_add_u32 s12, s9, 4096
    buffer_load_dwordx4 v[112:115], v4, s[44:47], s12 offen sc1
    buffer_load_dwordx4 v[208:211], v5, s[44:47], s12 offen sc1
    buffer_load_dwordx4 v[212:215], v6, s[44:47], s12 offen sc1
    buffer_load_dwordx4 v[216:219], v7, s[44:47], s12 offen sc1
    v_mov_b32 v3, s73
    s_mov_b32 s71, 0x200000
.pg_35:
    ds_read_b32 v2, v3
    s_waitcnt lgkmcnt(0)
    v_readfirstlane_b32 s70, v2
    s_nop 0
    s_cmp_ge_u32 s70, s75
    s_cbranch_scc1 .pge_36
    s_sleep 1
    s_sub_u32 s71, s71, 1
    s_cbranch_scc0 .pg_35
.pge_36:
    s_waitcnt vmcnt(15)
    v_mfma_f32_16x16x32_bf16 v[16:19], v[224:227], v[116:119], v[16:19]
    s_waitcnt vmcnt(14)
    v_mfma_f32_16x16x32_bf16 v[36:39], v[228:231], v[116:119], v[36:39]
    s_waitcnt vmcnt(13)
    v_mfma_f32_16x16x32_bf16 v[56:59], v[232:235], v[116:119], v[56:59]
    s_waitcnt vmcnt(12)
    v_mfma_f32_16x16x32_bf16 v[76:79], v[236:239], v[116:119], v[76:79]
    v_mfma_f32_16x16x32_bf16 v[20:23], v[224:227], v[120:123], v[20:23]
    v_mfma_f32_16x16x32_bf16 v[40:43], v[228:231], v[120:123], v[40:43]
    s_add_u32 s12, s9, 8192
    buffer_load_dwordx4 v[220:223], v4, s[44:47], s12 offen sc1
    v_mfma_f32_16x16x32_bf16 v[60:63], v[232:235], v[120:123], v[60:63]
    v_mfma_f32_16x16x32_bf16 v[80:83], v[236:239], v[120:123], v[80:83]
    v_mfma_f32_16x16x32_bf16 v[24:27], v[224:227], v[124:127], v[24:27]
    v_mfma_f32_16x16x32_bf16 v[44:47], v[228:231], v[124:127], v[44:47]
    buffer_load_dwordx4 v[116:119], v5, s[44:47], s12 offen sc1
    v_mfma_f32_16x16x32_bf16 v[64:67], v[232:235], v[124:127], v[64:67]
    v_mfma_f32_16x16x32_bf16 v[84:87], v[236:239], v[124:127], v[84:87]
    v_mfma_f32_16x16x32_bf16 v[28:31], v[224:227], v[128:131], v[28:31]
    v_mfma_f32_16x16x32_bf16 v[48:51], v[228:231], v[128:131], v[48:51]
    buffer_load_dwordx4 v[120:123], v6, s[44:47], s12 offen sc1
    v_mfma_f32_16x16x32_bf16 v[68:71], v[232:235], v[128:131], v[68:71]
    v_mfma_f32_16x16x32_bf16 v[88:91], v[236:239], v[128:131], v[88:91]
    v_mfma_f32_16x16x32_bf16 v[32:35], v[224:227], v[132:135], v[32:35]
    v_mfma_f32_16x16x32_bf16 v[52:55], v[228:231], v[132:135], v[52:55]
    buffer_load_dwordx4 v[124:127], v7, s[44:47], s12 offen sc1
    v_mfma_f32_16x16x32_bf16 v[72:75], v[232:235], v[132:135], v[72:75]
    v_mfma_f32_16x16x32_bf16 v[92:95], v[236:239], v[132:135], v[92:95]
    s_waitcnt vmcnt(15)
    v_mfma_f32_16x16x32_bf16 v[16:19], v[240:243], v[136:139], v[16:19]
    s_waitcnt vmcnt(14)
    v_mfma_f32_16x16x32_bf16 v[36:39], v[244:247], v[136:139], v[36:39]
    buffer_load_dwordx4 v[128:131], v4, s[44:47], s10 offen sc1
    s_waitcnt vmcnt(14)
    v_mfma_f32_16x16x32_bf16 v[56:59], v[248:251], v[136:139], v[56:59]
    s_waitcnt vmcnt(13)
    v_mfma_f32_16x16x32_bf16 v[76:79], v[252:255], v[136:139], v[76:79]
    v_mfma_f32_16x16x32_bf16 v[20:23], v[240:243], v[140:143], v[20:23]
    v_mfma_f32_16x16x32_bf16 v[40:43], v[244:247], v[140:143], v[40:43]
    buffer_load_dwordx4 v[132:135], v5, s[44:47], s10 offen sc1
    v_mfma_f32_16x16x32_bf16 v[60:63], v[248:251], v[140:143], v[60:63]
    v_mfma_f32_16x16x32_bf16 v[80:83], v[252:255], v[140:143], v[80:83]
    v_mfma_f32_16x16x32_bf16 v[24:27], v[240:243], v[144:147], v[24:27]
    v_mfma_f32_16x16x32_bf16 v[44:47], v[244:247], v[144:147], v[44:47]
    buffer_load_dwordx4 v[224:227], v6, s[44:47], s10 offen sc1
    v_mfma_f32_16x16x32_bf16 v[64:67], v[248:251], v[144:147], v[64:67]
    v_mfma_f32_16x16x32_bf16 v[84:87], v[252:255], v[144:147], v[84:87]
    v_mfma_f32_16x16x32_bf16 v[28:31], v[240:243], v[148:151], v[28:31]
    v_mfma_f32_16x16x32_bf16 v[48:51], v[244:247], v[148:151], v[48:51]
    buffer_load_dwordx4 v[228:231], v7, s[44:47], s10 offen sc1
    v_mfma_f32_16x16x32_bf16 v[68:71], v[248:251], v[148:151], v[68:71]
    v_mfma_f32_16x16x32_bf16 v[88:91], v[252:255], v[148:151], v[88:91]
    v_mfma_f32_16x16x32_bf16 v[32:35], v[240:243], v[152:155], v[32:35]
    v_mfma_f32_16x16x32_bf16 v[52:55], v[244:247], v[152:155], v[52:55]
    s_add_u32 s12, s10, 4096
    buffer_load_dwordx4 v[232:235], v4, s[44:47], s12 offen sc1
    v_mfma_f32_16x16x32_bf16 v[72:75], v[248:251], v[152:155], v[72:75]
    v_mfma_f32_16x16x32_bf16 v[92:95], v[252:255], v[152:155], v[92:95]
    s_waitcnt vmcnt(16)
    v_mfma_f32_16x16x32_bf16 v[16:19], v[96:99], v[156:159], v[16:19]
    s_waitcnt vmcnt(15)
    v_mfma_f32_16x16x32_bf16 v[36:39], v[100:103], v[156:159], v[36:39]
    buffer_load_dwordx4 v[236:239], v5, s[44:47], s12 offen sc1
    s_waitcnt vmcnt(15)
    v_mfma_f32_16x16x32_bf16 v[56:59], v[104:107], v[156:159], v[56:59]
    s_waitcnt vmcnt(14)
    v_mfma_f32_16x16x32_bf16 v[76:79], v[108:111], v[156:159], v[76:79]
    buffer_load_dwordx4 v[136:139], v14, s[44:47], s13 offen offset:0 sc1
    v_mfma_f32_16x16x32_bf16 v[20:23], v[96:99], v[160:163], v[20:23]
    v_mfma_f32_16x16x32_bf16 v[40:43], v[100:103], v[160:163], v[40:43]
    buffer_load_dwordx4 v[140:143], v6, s[44:47], s12 offen sc1
    v_mfma_f32_16x16x32_bf16 v[60:63], v[104:107], v[160:163], v[60:63]
    v_mfma_f32_16x16x32_bf16 v[80:83], v[108:111], v[160:163], v[80:83]
    s_add_u32 s13, s7, 10240
    buffer_load_dwordx4 v[144:147], v1, s[44:47], s13 offen offset:0 sc1
    v_mfma_f32_16x16x32_bf16 v[24:27], v[96:99], v[164:167], v[24:27]
    v_mfma_f32_16x16x32_bf16 v[44:47], v[100:103], v[164:167], v[44:47]
    buffer_load_dwordx4 v[148:151], v7, s[44:47], s12 offen sc1
    v_mfma_f32_16x16x32_bf16 v[64:67], v[104:107], v[164:167], v[64:67]
    v_mfma_f32_16x16x32_bf16 v[84:87], v[108:111], v[164:167], v[84:87]
    buffer_load_dwordx4 v[152:155], v1, s[44:47], s13 offen offset:1024 sc1
    v_mfma_f32_16x16x32_bf16 v[28:31], v[96:99], v[168:171], v[28:31]
    v_mfma_f32_16x16x32_bf16 v[48:51], v[100:103], v[168:171], v[48:51]
    s_add_u32 s12, s10, 8192
    buffer_load_dwordx4 v[240:243], v4, s[44:47], s12 offen sc1
    v_mfma_f32_16x16x32_bf16 v[68:71], v[104:107], v[168:171], v[68:71]
    v_mfma_f32_16x16x32_bf16 v[88:91], v[108:111], v[168:171], v[88:91]
    buffer_load_dwordx4 v[244:247], v1, s[44:47], s13 offen offset:2048 sc1
    v_mfma_f32_16x16x32_bf16 v[32:35], v[96:99], v[172:175], v[32:35]
    v_mfma_f32_16x16x32_bf16 v[52:55], v[100:103], v[172:175], v[52:55]
    buffer_load_dwordx4 v[248:251], v5, s[44:47], s12 offen sc1
    v_mfma_f32_16x16x32_bf16 v[72:75], v[104:107], v[172:175], v[72:75]
    v_mfma_f32_16x16x32_bf16 v[92:95], v[108:111], v[172:175], v[92:95]
    buffer_load_dwordx4 v[252:255], v1, s[44:47], s13 offen offset:3072 sc1
    s_waitcnt vmcnt(22)
    v_mfma_f32_16x16x32_bf16 v[16:19], v[112:115], v[176:179], v[16:19]
    s_waitcnt vmcnt(21)
    v_mfma_f32_16x16x32_bf16 v[36:39], v[208:211], v[176:179], v[36:39]
    buffer_load_dwordx4 v[156:159], v6, s[44:47], s12 offen sc1
    s_waitcnt vmcnt(21)
    v_mfma_f32_16x16x32_bf16 v[56:59], v[212:215], v[176:179], v[56:59]
    s_waitcnt vmcnt(20)
    v_mfma_f32_16x16x32_bf16 v[76:79], v[216:219], v[176:179], v[76:79]
    buffer_load_dwordx4 v[160:163], v14, s[44:47], s13 offen offset:0 sc1
    v_mfma_f32_16x16x32_bf16 v[20:23], v[112:115], v[180:183], v[20:23]
    ds_read_b128 v[164:167], v11 offset:0
    v_mfma_f32_16x16x32_bf16 v[40:43], v[208:211], v[180:183], v[40:43]
    buffer_load_dwordx4 v[168:171], v7, s[44:47], s12 offen sc1
    v_mfma_f32_16x16x32_bf16 v[60:63], v[212:215], v[180:183], v[60:63]
    v_mfma_f32_16x16x32_bf16 v[80:83], v[216:219], v[180:183], v[80:83]
    v_mfma_f32_16x16x32_bf16 v[24:27], v[112:115], v[184:187], v[24:27]
    ds_read_b128 v[172:175], v11 offset:1024
    v_mfma_f32_16x16x32_bf16 v[44:47], v[208:211], v[184:187], v[44:47]
    buffer_load_dwordx4 v[96:99], v4, s[44:47], s11 offen sc1
    v_mfma_f32_16x16x32_bf16 v[64:67], v[212:215], v[184:187], v[64:67]
    v_mfma_f32_16x16x32_bf16 v[84:87], v[216:219], v[184:187], v[84:87]
    v_mfma_f32_16x16x32_bf16 v[28:31], v[112:115], v[188:191], v[28:31]
    ds_read_b128 v[100:103], v10 offset:4096
    v_mfma_f32_16x16x32_bf16 v[48:51], v[208:211], v[188:191], v[48:51]
    buffer_load_dwordx4 v[104:107], v5, s[44:47], s11 offen sc1
    v_mfma_f32_16x16x32_bf16 v[68:71], v[212:215], v[188:191], v[68:71]
    v_mfma_f32_16x16x32_bf16 v[88:91], v[216:219], v[188:191], v[88:91]
    v_mfma_f32_16x16x32_bf16 v[32:35], v[112:115], v[192:195], v[32:35]
    ds_read_b128 v[108:111], v10 offset:5120
    v_mfma_f32_16x16x32_bf16 v[52:55], v[208:211], v[192:195], v[52:55]
    buffer_load_dwordx4 v[176:179], v6, s[44:47], s11 offen sc1
    v_mfma_f32_16x16x32_bf16 v[72:75], v[212:215], v[192:195], v[72:75]
    v_mfma_f32_16x16x32_bf16 v[92:95], v[216:219], v[192:195], v[92:95]
    s_waitcnt vmcnt(24)
    v_mfma_f32_16x16x32_bf16 v[16:19], v[220:223], v[196:199], v[16:19]
    ds_read_b128 v[180:183], v10 offset:6144
    s_waitcnt vmcnt(23)
    v_mfma_f32_16x16x32_bf16 v[36:39], v[116:119], v[196:199], v[36:39]
    buffer_load_dwordx4 v[184:187], v7, s[44:47], s11 offen sc1
    s_waitcnt vmcnt(23)
    v_mfma_f32_16x16x32_bf16 v[56:59], v[120:123], v[196:199], v[56:59]
    s_waitcnt vmcnt(22)
    v_mfma_f32_16x16x32_bf16 v[76:79], v[124:127], v[196:199], v[76:79]
    v_mfma_f32_16x16x32_bf16 v[20:23], v[220:223], v[200:203], v[20:23]
    ds_read_b128 v[188:191], v10 offset:7168
    v_mfma_f32_16x16x32_bf16 v[40:43], v[116:119], v[200:203], v[40:43]
    s_add_u32 s12, s11, 4096
    buffer_load_dwordx4 v[192:195], v4, s[44:47], s12 offen sc1
    v_mfma_f32_16x16x32_bf16 v[60:63], v[120:123], v[200:203], v[60:63]
    v_mfma_f32_16x16x32_bf16 v[80:83], v[124:127], v[200:203], v[80:83]
    v_mfma_f32_16x16x32_bf16 v[24:27], v[220:223], v[204:207], v[24:27]
    ds_read_b128 v[112:115], v10 offset:8192
    v_mfma_f32_16x16x32_bf16 v[44:47], v[116:119], v[204:207], v[44:47]
    buffer_load_dwordx4 v[208:211], v5, s[44:47], s12 offen sc1
    v_mfma_f32_16x16x32_bf16 v[64:67], v[120:123], v[204:207], v[64:67]
    v_mfma_f32_16x16x32_bf16 v[84:87], v[124:127], v[204:207], v[84:87]
    s_waitcnt lgkmcnt(6)
    v_mfma_f32_16x16x32_bf16 v[28:31], v[220:223], v[164:167], v[28:31]
    ds_read_b128 v[212:215], v10 offset:9216
    v_mfma_f32_16x16x32_bf16 v[48:51], v[116:119], v[164:167], v[48:51]
    buffer_load_dwordx4 v[216:219], v6, s[44:47], s12 offen sc1
    v_mfma_f32_16x16x32_bf16 v[68:71], v[120:123], v[164:167], v[68:71]
    v_mfma_f32_16x16x32_bf16 v[88:91], v[124:127], v[164:167], v[88:91]
    s_waitcnt lgkmcnt(6)
    v_mfma_f32_16x16x32_bf16 v[32:35], v[220:223], v[172:175], v[32:35]
    ds_read_b128 v[196:199], v10 offset:10240
    v_mfma_f32_16x16x32_bf16 v[52:55], v[116:119], v[172:175], v[52:55]
    buffer_load_dwordx4 v[200:203], v7, s[44:47], s12 offen sc1
    v_mfma_f32_16x16x32_bf16 v[72:75], v[120:123], v[172:175], v[72:75]
    v_mfma_f32_16x16x32_bf16 v[92:95], v[124:127], v[172:175], v[92:95]
    s_waitcnt lgkmcnt(6)
    s_waitcnt vmcnt(25)
    v_mfma_f32_16x16x32_bf16 v[16:19], v[128:131], v[100:103], v[16:19]
    ds_read_b128 v[116:119], v10 offset:11264
    s_waitcnt vmcnt(24)
    v_mfma_f32_16x16x32_bf16 v[36:39], v[132:135], v[100:103], v[36:39]
    s_add_u32 s12, s11, 8192
    buffer_load_dwordx4 v[120:123], v4, s[44:47], s12 offen sc1
    s_waitcnt vmcnt(24)
    v_mfma_f32_16x16x32_bf16 v[56:59], v[224:227], v[100:103], v[56:59]
    buffer_load_dwordx2 v[204:205], v13, s[40:43], s20 offen
    s_waitcnt vmcnt(24)
    v_mfma_f32_16x16x32_bf16 v[76:79], v[228:231], v[100:103], v[76:79]
    s_waitcnt lgkmcnt(6)
    v_mfma_f32_16x16x32_bf16 v[20:23], v[128:131], v[108:111], v[20:23]
    ds_read_b128 v[124:127], v10 offset:0
    v_mfma_f32_16x16x32_bf16 v[40:43], v[132:135], v[108:111], v[40:43]
    buffer_load_ushort v172, v13, s[40:43], s24 offen
    v_mfma_f32_16x16x32_bf16 v[60:63], v[224:227], v[108:111], v[60:63]
    v_mfma_f32_16x16x32_bf16 v[80:83], v[228:231], v[108:111], v[80:83]
    buffer_load_dwordx2 v[206:207], v13, s[40:43], s21 offen
    s_waitcnt lgkmcnt(6)
    v_mfma_f32_16x16x32_bf16 v[24:27], v[128:131], v[180:183], v[24:27]
    ds_read_b128 v[100:103], v10 offset:1024
    v_mfma_f32_16x16x32_bf16 v[44:47], v[132:135], v[180:183], v[44:47]
    v_mfma_f32_16x16x32_bf16 v[64:67], v[224:227], v[180:183], v[64:67]
    buffer_load_ushort v173, v13, s[40:43], s25 offen
    v_mfma_f32_16x16x32_bf16 v[84:87], v[228:231], v[180:183], v[84:87]
    s_waitcnt lgkmcnt(6)
    v_mfma_f32_16x16x32_bf16 v[28:31], v[128:131], v[188:191], v[28:31]
    ds_read_b128 v[108:111], v10 offset:2048
    v_mfma_f32_16x16x32_bf16 v[48:51], v[132:135], v[188:191], v[48:51]
    buffer_load_dwordx2 v[164:165], v13, s[40:43], s22 offen
    v_mfma_f32_16x16x32_bf16 v[68:71], v[224:227], v[188:191], v[68:71]
    v_mfma_f32_16x16x32_bf16 v[88:91], v[228:231], v[188:191], v[88:91]
    buffer_load_ushort v174, v13, s[40:43], s26 offen
    s_waitcnt lgkmcnt(6)
    v_mfma_f32_16x16x32_bf16 v[32:35], v[128:131], v[112:115], v[32:35]
    ds_read_b128 v[180:183], v10 offset:3072
    v_mfma_f32_16x16x32_bf16 v[52:55], v[132:135], v[112:115], v[52:55]
    v_mfma_f32_16x16x32_bf16 v[72:75], v[224:227], v[112:115], v[72:75]
    buffer_load_dwordx2 v[166:167], v13, s[40:43], s23 offen
    v_mfma_f32_16x16x32_bf16 v[92:95], v[228:231], v[112:115], v[92:95]
    s_waitcnt lgkmcnt(6)
    s_waitcnt vmcnt(29)
    v_mfma_f32_16x16x32_bf16 v[16:19], v[232:235], v[212:215], v[16:19]
    ds_read_b128 v[188:191], v11 offset:2048
    s_waitcnt vmcnt(28)
    v_mfma_f32_16x16x32_bf16 v[36:39], v[236:239], v[212:215], v[36:39]
    buffer_load_dwordx4 v[112:115], v5, s[44:47], s12 offen sc1
    s_waitcnt vmcnt(27)
    v_mfma_f32_16x16x32_bf16 v[56:59], v[140:143], v[212:215], v[56:59]
    buffer_load_ushort v175, v13, s[40:43], s27 offen
    s_waitcnt vmcnt(26)
    v_mfma_f32_16x16x32_bf16 v[76:79], v[148:151], v[212:215], v[76:79]
    s_waitcnt lgkmcnt(6)
    v_mfma_f32_16x16x32_bf16 v[20:23], v[232:235], v[196:199], v[20:23]
    ds_read_b128 v[128:131], v11 offset:3072
    v_mfma_f32_16x16x32_bf16 v[40:43], v[236:239], v[196:199], v[40:43]
    buffer_load_dwordx4 v[132:135], v6, s[44:47], s12 offen sc1
    v_mfma_f32_16x16x32_bf16 v[60:63], v[140:143], v[196:199], v[60:63]
    global_load_dwordx2 v[220:221], v15, s[30:31]
    v_add_u32 v15, s76, v15
    v_mfma_f32_16x16x32_bf16 v[80:83], v[148:151], v[196:199], v[80:83]
    global_load_ushort v222, v15, s[30:31]
    s_waitcnt lgkmcnt(6)
    v_mfma_f32_16x16x32_bf16 v[24:27], v[232:235], v[116:119], v[24:27]
    ds_read_b128 v[224:227], v11 offset:4096
    v_mfma_f32_16x16x32_bf16 v[44:47], v[236:239], v[116:119], v[44:47]
    buffer_load_dwordx4 v[228:231], v7, s[44:47], s12 offen sc1
    v_mfma_f32_16x16x32_bf16 v[64:67], v[140:143], v[116:119], v[64:67]
    v_mfma_f32_16x16x32_bf16 v[84:87], v[148:151], v[116:119], v[84:87]
    s_waitcnt lgkmcnt(6)
    v_mfma_f32_16x16x32_bf16 v[28:31], v[232:235], v[124:127], v[28:31]
    ds_read_b128 v[212:215], v11 offset:5120
    v_mfma_f32_16x16x32_bf16 v[48:51], v[236:239], v[124:127], v[48:51]
    v_mfma_f32_16x16x32_bf16 v[68:71], v[140:143], v[124:127], v[68:71]
    v_mfma_f32_16x16x32_bf16 v[88:91], v[148:151], v[124:127], v[88:91]
    s_waitcnt lgkmcnt(6)
    v_mfma_f32_16x16x32_bf16 v[32:35], v[232:235], v[100:103], v[32:35]
    ds_read_b128 v[196:199], v11 offset:6144
    v_mfma_f32_16x16x32_bf16 v[52:55], v[236:239], v[100:103], v[52:55]
    v_mfma_f32_16x16x32_bf16 v[72:75], v[140:143], v[100:103], v[72:75]
    v_mfma_f32_16x16x32_bf16 v[92:95], v[148:151], v[100:103], v[92:95]
    v_mov_b32 v2, 13
    ds_write_b32 v8, v2
    s_waitcnt lgkmcnt(7)
    s_waitcnt vmcnt(28)
    v_mfma_f32_16x16x32_bf16 v[16:19], v[240:243], v[108:111], v[16:19]
    ds_read_b128 v[116:119], v11 offset:7168
    s_waitcnt vmcnt(26)
    v_mfma_f32_16x16x32_bf16 v[36:39], v[248:251], v[108:111], v[36:39]
    v_add_u32 v4, s84, v1
    s_waitcnt vmcnt(24)
    v_mfma_f32_16x16x32_bf16 v[56:59], v[156:159], v[108:111], v[56:59]
    ds_read_b128 v[124:127], v11 offset:8192
    s_waitcnt vmcnt(22)
    v_mfma_f32_16x16x32_bf16 v[76:79], v[168:171], v[108:111], v[76:79]
    v_add_u32_e64 v5, s85, v1
    s_waitcnt lgkmcnt(8)
    v_mfma_f32_16x16x32_bf16 v[20:23], v[240:243], v[180:183], v[20:23]
    ds_read_b128 v[100:103], v11 offset:9216
    v_mfma_f32_16x16x32_bf16 v[40:43], v[248:251], v[180:183], v[40:43]
    v_add_u32_e64 v6, s86, v1
    v_mfma_f32_16x16x32_bf16 v[60:63], v[156:159], v[180:183], v[60:63]
    ds_read_b128 v[232:235], v11 offset:10240
    v_mfma_f32_16x16x32_bf16 v[80:83], v[168:171], v[180:183], v[80:83]
    v_lshrrev_b32 v3, 4, v0
    v_lshl_add_u32 v3, v3, 3, s83
    s_waitcnt lgkmcnt(9)
    v_mfma_f32_16x16x32_bf16 v[24:27], v[240:243], v[188:191], v[24:27]
    ds_read_b128 v[236:239], v12 offset:0
    v_mfma_f32_16x16x32_bf16 v[44:47], v[248:251], v[188:191], v[44:47]
    v_and_b32_e64 v7, 15, v0
    v_mad_u32_u24 v2, v7, s82, v3
    v_mfma_f32_16x16x32_bf16 v[64:67], v[156:159], v[188:191], v[64:67]
    ds_read_b128 v[140:143], v12 offset:1024
    v_mfma_f32_16x16x32_bf16 v[84:87], v[168:171], v[188:191], v[84:87]
    v_lshl_add_u32 v3, v7, 7, v3
    v_lshrrev_b32 v7, 2, v7
    s_waitcnt lgkmcnt(10)
    v_mfma_f32_16x16x32_bf16 v[28:31], v[240:243], v[128:131], v[28:31]
    ds_read_b128 v[148:151], v12 offset:2048
    v_mfma_f32_16x16x32_bf16 v[48:51], v[248:251], v[128:131], v[48:51]
    v_lshl_add_u32 v3, v7, 4, v3
    v_mov_b32 v7, 456
    v_mfma_f32_16x16x32_bf16 v[68:71], v[156:159], v[128:131], v[68:71]
    v_mfma_f32_16x16x32_bf16 v[88:91], v[168:171], v[128:131], v[88:91]
    s_waitcnt lgkmcnt(10)
    v_mfma_f32_16x16x32_bf16 v[32:35], v[240:243], v[224:227], v[32:35]
    v_mfma_f32_16x16x32_bf16 v[52:55], v[248:251], v[224:227], v[52:55]
    v_mfma_f32_16x16x32_bf16 v[72:75], v[156:159], v[224:227], v[72:75]
    v_mfma_f32_16x16x32_bf16 v[92:95], v[168:171], v[224:227], v[92:95]
    s_waitcnt lgkmcnt(9)
    s_waitcnt vmcnt(21)
    v_mfma_f32_16x16x32_bf16 v[16:19], v[96:99], v[212:215], v[16:19]
    s_waitcnt vmcnt(20)
    v_mfma_f32_16x16x32_bf16 v[36:39], v[104:107], v[212:215], v[36:39]
    s_waitcnt vmcnt(19)
    v_mfma_f32_16x16x32_bf16 v[56:59], v[176:179], v[212:215], v[56:59]
    s_waitcnt vmcnt(18)
    v_mfma_f32_16x16x32_bf16 v[76:79], v[184:187], v[212:215], v[76:79]
    s_waitcnt lgkmcnt(8)
    v_mfma_f32_16x16x32_bf16 v[20:23], v[96:99], v[196:199], v[20:23]
    v_mfma_f32_16x16x32_bf16 v[40:43], v[104:107], v[196:199], v[40:43]
    v_mfma_f32_16x16x32_bf16 v[60:63], v[176:179], v[196:199], v[60:63]
    v_mfma_f32_16x16x32_bf16 v[80:83], v[184:187], v[196:199], v[80:83]
    s_waitcnt lgkmcnt(6)
    v_mfma_f32_16x16x32_bf16 v[24:27], v[96:99], v[116:119], v[24:27]
    v_mfma_f32_16x16x32_bf16 v[44:47], v[104:107], v[116:119], v[44:47]
    v_mfma_f32_16x16x32_bf16 v[64:67], v[176:179], v[116:119], v[64:67]
    v_mfma_f32_16x16x32_bf16 v[84:87], v[184:187], v[116:119], v[84:87]
    s_waitcnt lgkmcnt(5)
    v_mfma_f32_16x16x32_bf16 v[28:31], v[96:99], v[124:127], v[28:31]
    v_mfma_f32_16x16x32_bf16 v[48:51], v[104:107], v[124:127], v[48:51]
    v_mfma_f32_16x16x32_bf16 v[68:71], v[176:179], v[124:127], v[68:71]
    v_mfma_f32_16x16x32_bf16 v[88:91], v[184:187], v[124:127], v[88:91]
    s_waitcnt lgkmcnt(4)
    v_mfma_f32_16x16x32_bf16 v[32:35], v[96:99], v[100:103], v[32:35]
    v_mfma_f32_16x16x32_bf16 v[52:55], v[104:107], v[100:103], v[52:55]
    v_mfma_f32_16x16x32_bf16 v[72:75], v[176:179], v[100:103], v[72:75]
    v_mfma_f32_16x16x32_bf16 v[92:95], v[184:187], v[100:103], v[92:95]
    s_waitcnt lgkmcnt(3)
    s_waitcnt lgkmcnt(2)
    s_waitcnt lgkmcnt(1)
    s_waitcnt lgkmcnt(0)
    s_waitcnt vmcnt(16)
    v_mfma_f32_16x16x32_bf16 v[36:39], v[208:211], v[232:235], v[36:39]
    s_waitcnt vmcnt(5)
    v_mfma_f32_16x16x32_bf16 v[36:39], v[112:115], v[144:147], v[36:39]
    v_mfma_f32_16x16x32_bf16 v[40:43], v[208:211], v[236:239], v[40:43]
    v_mfma_f32_16x16x32_bf16 v[40:43], v[112:115], v[152:155], v[40:43]
    v_mfma_f32_16x16x32_bf16 v[44:47], v[208:211], v[140:143], v[44:47]
    s_waitcnt vmcnt(1)
    s_mov_b32 s79, 0xffff0000
    v_mfma_f32_16x16x32_bf16 v[44:47], v[112:115], v[244:247], v[44:47]
    v_lshlrev_b32 v108, 16, v204
    v_and_b32 v180, s79, v204
    v_mfma_f32_16x16x32_bf16 v[48:51], v[208:211], v[148:151], v[48:51]
    v_lshlrev_b32 v188, 16, v205
    v_and_b32_e64 v128, s79, v205
    v_mfma_f32_16x16x32_bf16 v[48:51], v[112:115], v[252:255], v[48:51]
    ds_write_b128 v10, v[36:39] offset:0
    v_mfma_f32_16x16x32_bf16 v[52:55], v[208:211], v[136:139], v[52:55]
    v_lshlrev_b32 v109, 16, v206
    v_and_b32 v181, s79, v206
    v_mfma_f32_16x16x32_bf16 v[52:55], v[112:115], v[160:163], v[52:55]
    ds_write_b128 v10, v[40:43] offset:1024
    v_mfma_f32_16x16x32_bf16 v[56:59], v[216:219], v[232:235], v[56:59]
    v_lshlrev_b32 v189, 16, v207
    v_and_b32 v129, s79, v207
    v_mfma_f32_16x16x32_bf16 v[56:59], v[132:135], v[144:147], v[56:59]
    ds_write_b128 v10, v[44:47] offset:2048
    v_mfma_f32_16x16x32_bf16 v[60:63], v[216:219], v[236:239], v[60:63]
    v_lshlrev_b32 v110, 16, v164
    v_and_b32 v182, s79, v164
    v_mfma_f32_16x16x32_bf16 v[60:63], v[132:135], v[152:155], v[60:63]
    ds_write_b128 v10, v[48:51] offset:3072
    v_mfma_f32_16x16x32_bf16 v[64:67], v[216:219], v[140:143], v[64:67]
    v_lshlrev_b32 v190, 16, v165
    v_and_b32 v130, s79, v165
    v_mfma_f32_16x16x32_bf16 v[64:67], v[132:135], v[244:247], v[64:67]
    ds_write_b128 v10, v[52:55] offset:4096
    v_mfma_f32_16x16x32_bf16 v[68:71], v[216:219], v[148:151], v[68:71]
    v_lshlrev_b32 v111, 16, v166
    v_and_b32 v183, s79, v166
    v_mfma_f32_16x16x32_bf16 v[68:71], v[132:135], v[252:255], v[68:71]
    ds_write_b128 v10, v[56:59] offset:5120
    v_mfma_f32_16x16x32_bf16 v[72:75], v[216:219], v[136:139], v[72:75]
    v_lshlrev_b32 v191, 16, v167
    v_and_b32 v131, s79, v167
    v_mfma_f32_16x16x32_bf16 v[72:75], v[132:135], v[160:163], v[72:75]
    ds_write_b128 v10, v[60:63] offset:6144
    v_mfma_f32_16x16x32_bf16 v[76:79], v[200:203], v[232:235], v[76:79]
    v_lshlrev_b32 v224, 16, v172
    v_lshlrev_b32_e64 v225, 16, v173
    s_waitcnt vmcnt(0)
    v_mfma_f32_16x16x32_bf16 v[76:79], v[228:231], v[144:147], v[76:79]
    ds_write_b128 v10, v[64:67] offset:7168
    v_mfma_f32_16x16x32_bf16 v[80:83], v[200:203], v[236:239], v[80:83]
    v_lshlrev_b32 v226, 16, v174
    v_lshlrev_b32 v227, 16, v175
    v_mfma_f32_16x16x32_bf16 v[80:83], v[228:231], v[152:155], v[80:83]
    ds_write_b128 v10, v[68:71] offset:8192
    v_mfma_f32_16x16x32_bf16 v[84:87], v[200:203], v[140:143], v[84:87]
    v_lshlrev_b32 v240, 16, v220
    v_and_b32 v241, s79, v220
    v_mfma_f32_16x16x32_bf16 v[84:87], v[228:231], v[244:247], v[84:87]
    ds_write_b128 v10, v[72:75] offset:9216
    v_mfma_f32_16x16x32_bf16 v[88:91], v[200:203], v[148:151], v[88:91]
    v_lshlrev_b32 v242, 16, v221
    v_and_b32 v243, s79, v221
    v_mfma_f32_16x16x32_bf16 v[88:91], v[228:231], v[252:255], v[88:91]
    ds_write_b128 v11, v[76:79] offset:0
    v_mfma_f32_16x16x32_bf16 v[92:95], v[200:203], v[136:139], v[92:95]
    v_lshlrev_b32_e64 v248, 16, v222
    v_mfma_f32_16x16x32_bf16 v[92:95], v[228:231], v[160:163], v[92:95]
    ds_write_b128 v11, v[80:83] offset:1024
    v_mfma_f32_16x16x32_bf16 v[16:19], v[192:195], v[232:235], v[16:19]
    v_mfma_f32_16x16x32_bf16 v[16:19], v[120:123], v[144:147], v[16:19]
    ds_write_b128 v11, v[84:87] offset:2048
    v_mfma_f32_16x16x32_bf16 v[20:23], v[192:195], v[236:239], v[20:23]
    v_mfma_f32_16x16x32_bf16 v[20:23], v[120:123], v[152:155], v[20:23]
    ds_write_b128 v11, v[88:91] offset:3072
    v_mfma_f32_16x16x32_bf16 v[24:27], v[192:195], v[140:143], v[24:27]
    v_mfma_f32_16x16x32_bf16 v[24:27], v[120:123], v[244:247], v[24:27]
    ds_write_b128 v11, v[92:95] offset:4096
    v_mfma_f32_16x16x32_bf16 v[28:31], v[192:195], v[148:151], v[28:31]
    v_mfma_f32_16x16x32_bf16 v[28:31], v[120:123], v[252:255], v[28:31]
    v_mfma_f32_16x16x32_bf16 v[32:35], v[192:195], v[136:139], v[32:35]
    v_mfma_f32_16x16x32_bf16 v[32:35], v[120:123], v[160:163], v[32:35]
    v_mov_b32_e64 v14, 14
    ds_write_b32 v8, v14
    ds_read_b32 v15, v9
    v_pk_add_f32 v[16:17], v[16:17], v[240:241] op_sel_hi:[1,0]
    v_pk_add_f32 v[18:19], v[18:19], v[240:241] op_sel_hi:[1,0]
    v_pk_add_f32 v[20:21], v[20:21], v[240:241] op_sel:[0,1] op_sel_hi:[1,1]
    v_pk_add_f32 v[22:23], v[22:23], v[240:241] op_sel:[0,1] op_sel_hi:[1,1]
    v_pk_add_f32 v[24:25], v[24:25], v[242:243] op_sel_hi:[1,0]
    v_pk_add_f32 v[26:27], v[26:27], v[242:243] op_sel_hi:[1,0]
    v_pk_add_f32 v[28:29], v[28:29], v[242:243] op_sel:[0,1] op_sel_hi:[1,1]
    v_pk_add_f32 v[30:31], v[30:31], v[242:243] op_sel:[0,1] op_sel_hi:[1,1]
    v_pk_add_f32 v[32:33], v[32:33], v[248:249] op_sel_hi:[1,0]
    v_pk_add_f32 v[34:35], v[34:35], v[248:249] op_sel_hi:[1,0]
    s_waitcnt lgkmcnt(0)
    v_cmp_gt_u32 vcc, 14, v15
    s_cbranch_vccnz .br_37
.bb_38:
    s_nop 0
    ds_read_b128 v[36:39], v4 offset:0
    ds_read_b128 v[40:43], v4 offset:1024
    ds_read_b128 v[44:47], v4 offset:2048
    ds_read_b128 v[48:51], v4 offset:3072
    ds_read_b128 v[52:55], v4 offset:4096
    ds_read_b128 v[56:59], v5 offset:0
    ds_read_b128 v[60:63], v5 offset:1024
    ds_read_b128 v[64:67], v5 offset:2048
    ds_read_b128 v[68:71], v5 offset:3072
    ds_read_b128 v[72:75], v5 offset:4096
    ds_read_b128 v[76:79], v6 offset:0
    ds_read_b128 v[80:83], v6 offset:1024
    ds_read_b128 v[84:87], v6 offset:2048
    ds_read_b128 v[88:91], v6 offset:3072
    ds_read_b128 v[92:95], v6 offset:4096
    s_waitcnt lgkmcnt(10)
    s_nop 0
    v_pk_add_f32 v[16:17], v[16:17], v[36:37]
    v_pk_add_f32 v[18:19], v[18:19], v[38:39]
    v_pk_add_f32 v[20:21], v[20:21], v[40:41]
    v_pk_add_f32 v[22:23], v[22:23], v[42:43]
    v_pk_add_f32 v[24:25], v[24:25], v[44:45]
    v_pk_add_f32 v[26:27], v[26:27], v[46:47]
    v_pk_add_f32 v[28:29], v[28:29], v[48:49]
    v_pk_add_f32 v[30:31], v[30:31], v[50:51]
    v_pk_add_f32 v[32:33], v[32:33], v[52:53]
    v_pk_add_f32 v[34:35], v[34:35], v[54:55]
    s_waitcnt lgkmcnt(5)
    s_nop 0
    v_pk_add_f32 v[16:17], v[16:17], v[56:57]
    v_pk_add_f32 v[18:19], v[18:19], v[58:59]
    v_pk_add_f32 v[20:21], v[20:21], v[60:61]
    v_pk_add_f32 v[22:23], v[22:23], v[62:63]
    v_pk_add_f32 v[24:25], v[24:25], v[64:65]
    v_pk_add_f32 v[26:27], v[26:27], v[66:67]
    v_pk_add_f32 v[28:29], v[28:29], v[68:69]
    v_pk_add_f32 v[30:31], v[30:31], v[70:71]
    v_pk_add_f32 v[32:33], v[32:33], v[72:73]
    v_pk_add_f32 v[34:35], v[34:35], v[74:75]
    s_waitcnt lgkmcnt(0)
    s_nop 0
    v_pk_add_f32 v[16:17], v[16:17], v[76:77]
    v_pk_add_f32 v[18:19], v[18:19], v[78:79]
    v_pk_add_f32 v[20:21], v[20:21], v[80:81]
    v_pk_add_f32 v[22:23], v[22:23], v[82:83]
    v_pk_add_f32 v[24:25], v[24:25], v[84:85]
    v_pk_add_f32 v[26:27], v[26:27], v[86:87]
    v_pk_add_f32 v[28:29], v[28:29], v[88:89]
    v_pk_add_f32 v[30:31], v[30:31], v[90:91]
    v_pk_add_f32 v[32:33], v[32:33], v[92:93]
    v_pk_add_f32 v[34:35], v[34:35], v[94:95]
    s_mov_b32 s72, 0xbfb8aa3b
    s_mov_b32 s73, 0xc2ae0000
    s_mov_b32 s74, 0x14000000
    v_pk_fma_f32 v[36:37], v[16:17], s[72:73], s[72:73] op_sel:[0,0,1] op_sel_hi:[1,0,1]
    v_pk_fma_f32 v[38:39], v[18:19], s[72:73], s[72:73] op_sel:[0,0,1] op_sel_hi:[1,0,1]
    v_pk_fma_f32 v[40:41], v[20:21], s[72:73], s[72:73] op_sel:[0,0,1] op_sel_hi:[1,0,1]
    v_pk_fma_f32 v[42:43], v[22:23], s[72:73], s[72:73] op_sel:[0,0,1] op_sel_hi:[1,0,1]
    v_pk_fma_f32 v[44:45], v[24:25], s[72:73], s[72:73] op_sel:[0,0,1] op_sel_hi:[1,0,1]
    v_pk_fma_f32 v[46:47], v[26:27], s[72:73], s[72:73] op_sel:[0,0,1] op_sel_hi:[1,0,1]
    v_pk_fma_f32 v[48:49], v[28:29], s[72:73], s[72:73] op_sel:[0,0,1] op_sel_hi:[1,0,1]
    v_pk_fma_f32 v[50:51], v[30:31], s[72:73], s[72:73] op_sel:[0,0,1] op_sel_hi:[1,0,1]
    v_pk_fma_f32 v[52:53], v[32:33], s[72:73], s[72:73] op_sel:[0,0,1] op_sel_hi:[1,0,1]
    v_pk_fma_f32 v[54:55], v[34:35], s[72:73], s[72:73] op_sel:[0,0,1] op_sel_hi:[1,0,1]
    v_exp_f32 v36, v36
    v_exp_f32 v37, v37
    v_exp_f32 v38, v38
    v_exp_f32 v39, v39
    v_exp_f32 v40, v40
    v_exp_f32 v41, v41
    v_exp_f32 v42, v42
    v_exp_f32 v43, v43
    v_exp_f32 v44, v44
    v_exp_f32 v45, v45
    v_exp_f32 v46, v46
    v_exp_f32 v47, v47
    v_exp_f32 v48, v48
    v_exp_f32 v49, v49
    v_exp_f32 v50, v50
    v_exp_f32 v51, v51
    v_exp_f32 v52, v52
    v_exp_f32 v53, v53
    v_exp_f32 v54, v54
    v_exp_f32 v55, v55
    v_pk_add_f32 v[36:37], v[36:37], s[74:75] op_sel_hi:[1,0]
    v_pk_add_f32 v[38:39], v[38:39], s[74:75] op_sel_hi:[1,0]
    v_pk_add_f32 v[40:41], v[40:41], s[74:75] op_sel_hi:[1,0]
    v_pk_add_f32 v[42:43], v[42:43], s[74:75] op_sel_hi:[1,0]
    v_pk_add_f32 v[44:45], v[44:45], s[74:75] op_sel_hi:[1,0]
    v_pk_add_f32 v[46:47], v[46:47], s[74:75] op_sel_hi:[1,0]
    v_pk_add_f32 v[48:49], v[48:49], s[74:75] op_sel_hi:[1,0]
    v_pk_add_f32 v[50:51], v[50:51], s[74:75] op_sel_hi:[1,0]
    v_pk_add_f32 v[52:53], v[52:53], s[74:75] op_sel_hi:[1,0]
    v_pk_add_f32 v[54:55], v[54:55], s[74:75] op_sel_hi:[1,0]
    v_rcp_f32 v36, v36
    v_rcp_f32 v37, v37
    v_rcp_f32 v38, v38
    v_rcp_f32 v39, v39
    v_rcp_f32 v40, v40
    v_rcp_f32 v41, v41
    ds_read_b32 v12, v7
    ds_read_b64 v[156:157], v2 offset:0
    ds_read_b64 v[158:159], v2 offset:128
    ds_read_b64 v[168:169], v2 offset:256
    ds_read_b64 v[170:171], v2 offset:384
    ds_read_b64 v[212:213], v3 offset:8448
    v_rcp_f32 v42, v42
    v_rcp_f32 v43, v43
    v_rcp_f32 v44, v44
    v_rcp_f32 v45, v45
    v_rcp_f32 v46, v46
    v_rcp_f32 v47, v47
    v_rcp_f32 v48, v48
    v_rcp_f32 v49, v49
    v_rcp_f32 v50, v50
    v_rcp_f32 v51, v51
    v_rcp_f32 v52, v52
    v_rcp_f32 v53, v53
    v_rcp_f32 v54, v54
    v_rcp_f32 v55, v55
    v_pk_mul_f32 v[16:17], v[16:17], v[36:37]
    v_pk_mul_f32 v[18:19], v[18:19], v[38:39]
    v_pk_mul_f32 v[20:21], v[20:21], v[40:41]
    v_pk_mul_f32 v[22:23], v[22:23], v[42:43]
    v_pk_mul_f32 v[24:25], v[24:25], v[44:45]
    v_pk_mul_f32 v[26:27], v[26:27], v[46:47]
    v_pk_mul_f32 v[28:29], v[28:29], v[48:49]
    v_pk_mul_f32 v[30:31], v[30:31], v[50:51]
    v_pk_mul_f32 v[32:33], v[32:33], v[52:53]
    v_pk_mul_f32 v[34:35], v[34:35], v[54:55]
    s_waitcnt lgkmcnt(0)
    v_cmp_eq_u32 vcc, 0, v12
    s_cbranch_vccnz .rt_39
.rb_40:
    v_lshlrev_b32 v196, 16, v156
    v_and_b32 v197, s79, v156
    v_lshlrev_b32 v116, 16, v158
    v_and_b32 v117, s79, v158
    v_lshlrev_b32 v124, 16, v168
    v_and_b32 v125, s79, v168
    v_lshlrev_b32 v100, 16, v170
    v_and_b32 v101, s79, v170
    v_lshlrev_b32 v96, 16, v212
    v_and_b32_e64 v97, s79, v212
    v_pk_fma_f32 v[16:17], v[16:17], v[196:197], v[108:109]
    v_pk_fma_f32 v[20:21], v[20:21], v[116:117], v[180:181]
    v_pk_fma_f32 v[24:25], v[24:25], v[124:125], v[188:189]
    v_pk_fma_f32 v[28:29], v[28:29], v[100:101], v[128:129]
    v_pk_fma_f32 v[32:33], v[32:33], v[96:97], v[224:225]
    v_cvt_pk_bf16_f32 v68, v32, v33
    v_cvt_pk_bf16_f32 v60, v16, v20
    v_cvt_pk_bf16_f32 v61, v24, v28
    buffer_store_dwordx2 v[60:61], v13, s[56:59], s20 offen
    buffer_store_short v68, v13, s[56:59], s24 offen
    v_cvt_pk_bf16_f32 v62, v17, v21
    v_cvt_pk_bf16_f32 v63, v25, v29
    buffer_store_dwordx2 v[62:63], v13, s[56:59], s21 offen
    buffer_store_short_d16_hi v68, v13, s[56:59], s25 offen
    v_lshlrev_b32 v198, 16, v157
    v_and_b32 v199, s79, v157
    v_lshlrev_b32 v118, 16, v159
    v_and_b32 v119, s79, v159
    v_lshlrev_b32 v126, 16, v169
    v_and_b32 v127, s79, v169
    v_lshlrev_b32 v102, 16, v171
    v_and_b32 v103, s79, v171
    v_lshlrev_b32 v98, 16, v213
    v_and_b32 v99, s79, v213
    v_pk_fma_f32 v[18:19], v[18:19], v[198:199], v[110:111]
    v_pk_fma_f32 v[22:23], v[22:23], v[118:119], v[182:183]
    v_pk_fma_f32 v[26:27], v[26:27], v[126:127], v[190:191]
    v_pk_fma_f32 v[30:31], v[30:31], v[102:103], v[130:131]
    v_pk_fma_f32 v[34:35], v[34:35], v[98:99], v[226:227]
    v_cvt_pk_bf16_f32 v69, v34, v35
    v_cvt_pk_bf16_f32 v64, v18, v22
    v_cvt_pk_bf16_f32 v65, v26, v30
    buffer_store_dwordx2 v[64:65], v13, s[56:59], s22 offen
    buffer_store_short v69, v13, s[56:59], s26 offen
    v_cvt_pk_bf16_f32 v66, v19, v23
    v_cvt_pk_bf16_f32 v67, v27, v31
    buffer_store_dwordx2 v[66:67], v13, s[56:59], s23 offen
    buffer_store_short_d16_hi v69, v13, s[56:59], s27 offen
    s_endpgm
.Lhelper:
    s_lshr_b32 s70, s60, 1
    s_lshl_b32 s70, s70, 3
    s_and_b32 s71, s61, 7
    s_add_u32 s64, s70, s71
    s_and_b32 s70, s60, 1
    s_lshl_b32 s70, s70, 2
    s_lshr_b32 s71, s61, 3
    s_add_u32 s65, s70, s71
    s_mul_i32 s72, s61, 86
    s_lshr_b32 s72, s72, 8
    s_mul_i32 s73, s72, 3
    s_sub_u32 s73, s61, s73
    s_mul_i32 s69, s60, 80
    s_sub_u32 s69, s69, s72
    s_mul_i32 s72, s61, 3
    s_add_u32 s69, s69, s72
    s_cmp_eq_u32 s73, 2
    s_cselect_b32 s68, 2, 3
    s_cmp_ge_u32 s61, 30
    s_cselect_b32 s68, 0, s68
    s_waitcnt vmcnt(16)
    v_readfirstlane_b32 s70, v3
    s_nop 0
    s_mul_i32 s70, s70, 0x9E3779B1
    s_add_u32 s86, s70, 0x7F4A7C15
    s_andn2_b32 s70, 1, s86
    s_lshl_b32 s70, s70, 2
    s_andn2_b32 s71, s86, 4
    s_or_b32 s67, s70, s71
    v_mov_b32 v3, s67
    v_mov_b32 v98, 448
    ds_write_b32 v98, v3
    s_waitcnt vmcnt(0)
    s_mov_b32 s79, 0xffff0000
    v_lshlrev_b32 v136, 16, v8
    v_and_b32 v137, s79, v8
    v_add_f32 v80, v136, v137
    v_mul_f32 v88, v136, v136
    v_fmac_f32 v88, v137, v137
    v_lshlrev_b32 v146, 16, v12
    v_and_b32 v147, s79, v12
    v_add_f32 v81, v146, v147
    v_mul_f32 v89, v146, v146
    v_fmac_f32 v89, v147, v147
    v_lshlrev_b32 v156, 16, v16
    v_and_b32 v157, s79, v16
    v_add_f32 v82, v156, v157
    v_mul_f32 v90, v156, v156
    v_fmac_f32 v90, v157, v157
    v_lshlrev_b32 v166, 16, v20
    v_and_b32 v167, s79, v20
    v_add_f32 v83, v166, v167
    v_mul_f32 v91, v166, v166
    v_fmac_f32 v91, v167, v167
    v_lshlrev_b32 v176, 16, v24
    v_and_b32 v177, s79, v24
    v_add_f32 v84, v176, v177
    v_mul_f32 v92, v176, v176
    v_fmac_f32 v92, v177, v177
    v_lshlrev_b32 v186, 16, v28
    v_and_b32 v187, s79, v28
    v_add_f32 v85, v186, v187
    v_mul_f32 v93, v186, v186
    v_fmac_f32 v93, v187, v187
    v_lshlrev_b32 v196, 16, v32
    v_and_b32 v197, s79, v32
    v_add_f32 v86, v196, v197
    v_mul_f32 v94, v196, v196
    v_fmac_f32 v94, v197, v197
    v_lshlrev_b32 v206, 16, v36
    v_and_b32 v207, s79, v36
    v_add_f32 v87, v206, v207
    v_mul_f32 v95, v206, v206
    v_fmac_f32 v95, v207, v207
    v_lshlrev_b32 v138, 16, v9
    v_and_b32 v139, s79, v9
    v_add_f32 v80, v80, v138
    v_fmac_f32 v88, v138, v138
    v_add_f32 v80, v80, v139
    v_fmac_f32 v88, v139, v139
    v_lshlrev_b32 v148, 16, v13
    v_and_b32 v149, s79, v13
    v_add_f32 v81, v81, v148
    v_fmac_f32 v89, v148, v148
    v_add_f32 v81, v81, v149
    v_fmac_f32 v89, v149, v149
    v_lshlrev_b32 v158, 16, v17
    v_and_b32 v159, s79, v17
    v_add_f32 v82, v82, v158
    v_fmac_f32 v90, v158, v158
    v_add_f32 v82, v82, v159
    v_fmac_f32 v90, v159, v159
    v_lshlrev_b32 v168, 16, v21
    v_and_b32 v169, s79, v21
    v_add_f32 v83, v83, v168
    v_fmac_f32 v91, v168, v168
    v_add_f32 v83, v83, v169
    v_fmac_f32 v91, v169, v169
    v_lshlrev_b32 v178, 16, v25
    v_and_b32 v179, s79, v25
    v_add_f32 v84, v84, v178
    v_fmac_f32 v92, v178, v178
    v_add_f32 v84, v84, v179
    v_fmac_f32 v92, v179, v179
    v_lshlrev_b32 v188, 16, v29
    v_and_b32 v189, s79, v29
    v_add_f32 v85, v85, v188
    v_fmac_f32 v93, v188, v188
    v_add_f32 v85, v85, v189
    v_fmac_f32 v93, v189, v189
    v_lshlrev_b32 v198, 16, v33
    v_and_b32 v199, s79, v33
    v_add_f32 v86, v86, v198
    v_fmac_f32 v94, v198, v198
    v_add_f32 v86, v86, v199
    v_fmac_f32 v94, v199, v199
    v_lshlrev_b32 v208, 16, v37
    v_and_b32 v209, s79, v37
    v_add_f32 v87, v87, v208
    v_fmac_f32 v95, v208, v208
    v_add_f32 v87, v87, v209
    v_fmac_f32 v95, v209, v209
    v_lshlrev_b32 v140, 16, v10
    v_and_b32 v141, s79, v10
    v_add_f32 v80, v80, v140
    v_fmac_f32 v88, v140, v140
    v_add_f32 v80, v80, v141
    v_fmac_f32 v88, v141, v141
    v_lshlrev_b32 v150, 16, v14
    v_and_b32 v151, s79, v14
    v_add_f32 v81, v81, v150
    v_fmac_f32 v89, v150, v150
    v_add_f32 v81, v81, v151
    v_fmac_f32 v89, v151, v151
    v_lshlrev_b32 v160, 16, v18
    v_and_b32 v161, s79, v18
    v_add_f32 v82, v82, v160
    v_fmac_f32 v90, v160, v160
    v_add_f32 v82, v82, v161
    v_fmac_f32 v90, v161, v161
    v_lshlrev_b32 v170, 16, v22
    v_and_b32 v171, s79, v22
    v_add_f32 v83, v83, v170
    v_fmac_f32 v91, v170, v170
    v_add_f32 v83, v83, v171
    v_fmac_f32 v91, v171, v171
    v_lshlrev_b32 v180, 16, v26
    v_and_b32 v181, s79, v26
    v_add_f32 v84, v84, v180
    v_fmac_f32 v92, v180, v180
    v_add_f32 v84, v84, v181
    v_fmac_f32 v92, v181, v181
    v_lshlrev_b32 v190, 16, v30
    v_and_b32 v191, s79, v30
    v_add_f32 v85, v85, v190
    v_fmac_f32 v93, v190, v190
    v_add_f32 v85, v85, v191
    v_fmac_f32 v93, v191, v191
    v_lshlrev_b32 v200, 16, v34
    v_and_b32 v201, s79, v34
    v_add_f32 v86, v86, v200
    v_fmac_f32 v94, v200, v200
    v_add_f32 v86, v86, v201
    v_fmac_f32 v94, v201, v201
    v_lshlrev_b32 v210, 16, v38
    v_and_b32 v211, s79, v38
    v_add_f32 v87, v87, v210
    v_fmac_f32 v95, v210, v210
    v_add_f32 v87, v87, v211
    v_fmac_f32 v95, v211, v211
    v_lshlrev_b32 v142, 16, v11
    v_and_b32 v143, s79, v11
    v_add_f32 v80, v80, v142
    v_fmac_f32 v88, v142, v142
    v_add_f32 v80, v80, v143
    v_fmac_f32 v88, v143, v143
    v_lshlrev_b32 v152, 16, v15
    v_and_b32 v153, s79, v15
    v_add_f32 v81, v81, v152
    v_fmac_f32 v89, v152, v152
    v_add_f32 v81, v81, v153
    v_fmac_f32 v89, v153, v153
    v_lshlrev_b32 v162, 16, v19
    v_and_b32 v163, s79, v19
    v_add_f32 v82, v82, v162
    v_fmac_f32 v90, v162, v162
    v_add_f32 v82, v82, v163
    v_fmac_f32 v90, v163, v163
    v_lshlrev_b32 v172, 16, v23
    v_and_b32 v173, s79, v23
    v_add_f32 v83, v83, v172
    v_fmac_f32 v91, v172, v172
    v_add_f32 v83, v83, v173
    v_fmac_f32 v91, v173, v173
    v_lshlrev_b32 v182, 16, v27
    v_and_b32 v183, s79, v27
    v_add_f32 v84, v84, v182
    v_fmac_f32 v92, v182, v182
    v_add_f32 v84, v84, v183
    v_fmac_f32 v92, v183, v183
    v_lshlrev_b32 v192, 16, v31
    v_and_b32 v193, s79, v31
    v_add_f32 v85, v85, v192
    v_fmac_f32 v93, v192, v192
    v_add_f32 v85, v85, v193
    v_fmac_f32 v93, v193, v193
    v_lshlrev_b32 v202, 16, v35
    v_and_b32 v203, s79, v35
    v_add_f32 v86, v86, v202
    v_fmac_f32 v94, v202, v202
    v_add_f32 v86, v86, v203
    v_fmac_f32 v94, v203, v203
    v_lshlrev_b32 v212, 16, v39
    v_and_b32 v213, s79, v39
    v_add_f32 v87, v87, v212
    v_fmac_f32 v95, v212, v212
    v_add_f32 v87, v87, v213
    v_fmac_f32 v95, v213, v213
    v_lshlrev_b32 v144, 16, v40
    v_and_b32 v145, s79, v40
    v_add_f32 v80, v80, v144
    v_fmac_f32 v88, v144, v144
    v_add_f32 v80, v80, v145
    v_fmac_f32 v88, v145, v145
    v_lshlrev_b32 v154, 16, v41
    v_and_b32 v155, s79, v41
    v_add_f32 v81, v81, v154
    v_fmac_f32 v89, v154, v154
    v_add_f32 v81, v81, v155
    v_fmac_f32 v89, v155, v155
    v_lshlrev_b32 v164, 16, v42
    v_and_b32 v165, s79, v42
    v_add_f32 v82, v82, v164
    v_fmac_f32 v90, v164, v164
    v_add_f32 v82, v82, v165
    v_fmac_f32 v90, v165, v165
    v_lshlrev_b32 v174, 16, v43
    v_and_b32 v175, s79, v43
    v_add_f32 v83, v83, v174
    v_fmac_f32 v91, v174, v174
    v_add_f32 v83, v83, v175
    v_fmac_f32 v91, v175, v175
    v_lshlrev_b32 v184, 16, v44
    v_and_b32 v185, s79, v44
    v_add_f32 v84, v84, v184
    v_fmac_f32 v92, v184, v184
    v_add_f32 v84, v84, v185
    v_fmac_f32 v92, v185, v185
    v_lshlrev_b32 v194, 16, v45
    v_and_b32 v195, s79, v45
    v_add_f32 v85, v85, v194
    v_fmac_f32 v93, v194, v194
    v_add_f32 v85, v85, v195
    v_fmac_f32 v93, v195, v195
    v_lshlrev_b32 v204, 16, v46
    v_and_b32 v205, s79, v46
    v_add_f32 v86, v86, v204
    v_fmac_f32 v94, v204, v204
    v_add_f32 v86, v86, v205
    v_fmac_f32 v94, v205, v205
    v_lshlrev_b32 v214, 16, v47
    v_and_b32 v215, s79, v47
    v_add_f32 v87, v87, v214
    v_fmac_f32 v95, v214, v214
    v_add_f32 v87, v87, v215
    v_fmac_f32 v95, v215, v215
    v_permlane32_swap_b32 v80, v82
    v_permlane32_swap_b32 v81, v83
    v_permlane32_swap_b32 v84, v86
    v_permlane32_swap_b32 v85, v87
    v_permlane32_swap_b32 v88, v90
    v_permlane32_swap_b32 v89, v91
    v_permlane32_swap_b32 v92, v94
    v_permlane32_swap_b32 v93, v95
    v_add_f32 v80, v80, v82
    v_add_f32 v81, v81, v83
    v_add_f32 v84, v84, v86
    v_add_f32 v85, v85, v87
    v_add_f32 v88, v88, v90
    v_add_f32 v89, v89, v91
    v_add_f32 v92, v92, v94
    v_add_f32 v93, v93, v95
    v_permlane16_swap_b32 v80, v81
    v_permlane16_swap_b32 v84, v85
    v_permlane16_swap_b32 v88, v89
    v_permlane16_swap_b32 v92, v93
    v_add_f32 v80, v80, v81
    v_add_f32 v84, v84, v85
    v_add_f32 v88, v88, v89
    v_add_f32 v92, v92, v93
    v_add_f32_dpp v80, v80, v80 row_ror:8 row_mask:0xf bank_mask:0xf
    v_add_f32_dpp v84, v84, v84 row_ror:8 row_mask:0xf bank_mask:0xf
    v_add_f32_dpp v88, v88, v88 row_ror:8 row_mask:0xf bank_mask:0xf
    v_add_f32_dpp v92, v92, v92 row_ror:8 row_mask:0xf bank_mask:0xf
    v_add_f32_dpp v80, v80, v80 row_ror:4 row_mask:0xf bank_mask:0xf
    v_add_f32_dpp v84, v84, v84 row_ror:4 row_mask:0xf bank_mask:0xf
    v_add_f32_dpp v88, v88, v88 row_ror:4 row_mask:0xf bank_mask:0xf
    v_add_f32_dpp v92, v92, v92 row_ror:4 row_mask:0xf bank_mask:0xf
    v_add_f32_dpp v80, v80, v80 row_ror:2 row_mask:0xf bank_mask:0xf
    v_add_f32_dpp v84, v84, v84 row_ror:2 row_mask:0xf bank_mask:0xf
    v_add_f32_dpp v88, v88, v88 row_ror:2 row_mask:0xf bank_mask:0xf
    v_add_f32_dpp v92, v92, v92 row_ror:2 row_mask:0xf bank_mask:0xf
    v_add_f32_dpp v80, v80, v80 row_ror:1 row_mask:0xf bank_mask:0xf
    v_add_f32_dpp v84, v84, v84 row_ror:1 row_mask:0xf bank_mask:0xf
    v_add_f32_dpp v88, v88, v88 row_ror:1 row_mask:0xf bank_mask:0xf
    v_add_f32_dpp v92, v92, v92 row_ror:1 row_mask:0xf bank_mask:0xf
    s_mov_b32 s70, 0x3acccccd
    s_mov_b32 s71, 0x3727c5ac
    v_mul_f32 v80, s70, v80
    v_mul_f32 v84, s70, v84
    v_mul_f32 v88, s70, v88
    v_mul_f32 v92, s70, v92
    v_fma_f32 v88, -v80, v80, v88
    v_fma_f32 v92, -v84, v84, v92
    v_max_f32 v88, 0, v88
    v_max_f32 v92, 0, v92
    v_add_f32 v100, s71, v88
    v_add_f32 v108, s71, v92
    v_rsq_f32 v100, v100
    v_rsq_f32 v108, v108
    v_mul_f32 v88, v88, v100
    v_mul_f32 v92, v92, v108
    v_fma_f32 v88, v88, v100, s71
    v_fma_f32 v92, v92, v108, s71
    v_rsq_f32 v88, v88
    v_rsq_f32 v92, v92
    v_mul_f32 v101, -v80, v100
    v_mul_f32 v109, -v84, v108
    v_mul_f32 v96, v88, v100
    v_mul_f32 v104, v92, v108
    v_sub_f32 v97, 0, v80
    v_sub_f32 v105, 0, v84
    v_rcp_f32 v98, v96
    v_rcp_f32 v106, v104
    v_mov_b32 v99, s67
    v_mov_b32_e64 v107, s67
    s_lshl_b32 s80, s62, 4
    s_add_u32 s80, s80, s63
    s_lshl_b32 s70, s80, 7
    s_add_u32 s70, s70, 16384
    s_mov_b32 exec_lo, 0x00010001
    s_mov_b32 exec_hi, 0x00010001
    buffer_store_dwordx4 v[96:99], v0, s[44:47], s70 offen sc1
    buffer_store_dwordx4 v[104:107], v0, s[44:47], s70 offen offset:64 sc1
    s_mov_b64 exec, -1
    s_nop 0
    v_readlane_b32 s4, v100, 0
    v_readlane_b32 s5, v101, 0
    v_readlane_b32 s6, v100, 16
    v_readlane_b32 s7, v101, 16
    v_readlane_b32 s8, v100, 32
    v_readlane_b32 s9, v101, 32
    v_readlane_b32 s10, v100, 48
    v_readlane_b32 s11, v101, 48
    v_readlane_b32 s12, v108, 0
    v_readlane_b32 s13, v109, 0
    v_readlane_b32 s14, v108, 16
    v_readlane_b32 s15, v109, 16
    v_readlane_b32 s16, v108, 32
    v_readlane_b32 s17, v109, 32
    v_readlane_b32 s18, v108, 48
    v_readlane_b32 s19, v109, 48
    s_mul_i32 s70, s80, 10240
    s_add_u32 s70, s70, 1048576
    s_mov_b32 s71, 0xffff0000
    s_mov_b32 s81, 0x00030003
    s_lshr_b32 s82, s67, 0
    s_and_b32 s82, s82, s81
    v_mov_b32 v128, s82
    s_lshr_b32 s82, s67, 2
    s_and_b32 s82, s82, s81
    v_mov_b32 v129, s82
    s_lshr_b32 s82, s67, 4
    s_and_b32 s82, s82, s81
    v_mov_b32 v130, s82
    s_lshr_b32 s82, s67, 6
    s_and_b32 s82, s82, s81
    v_mov_b32 v131, s82
    v_mov_b32 v80, s5
    v_mov_b32 v81, s7
    v_mov_b32 v82, s9
    v_mov_b32 v83, s11
    v_mov_b32 v84, s13
    v_mov_b32 v85, s15
    v_mov_b32 v86, s17
    v_mov_b32 v87, s19
    v_fma_f32 v136, v136, s4, v80
    v_fma_f32 v146, v146, s6, v81
    v_fma_f32 v156, v156, s8, v82
    v_fma_f32 v166, v166, s10, v83
    v_fma_f32 v176, v176, s12, v84
    v_fma_f32 v186, v186, s14, v85
    v_fma_f32 v196, v196, s16, v86
    v_fma_f32 v206, v206, s18, v87
    v_cvt_pk_f16_f32 v112, v136, v146
    v_cvt_pk_f16_f32 v113, v156, v166
    v_cvt_pk_f16_f32 v114, v176, v186
    v_cvt_pk_f16_f32 v115, v196, v206
    v_bfi_b32 v112, s81, v128, v112
    v_bfi_b32 v113, s81, v129, v113
    v_bfi_b32 v114, s81, v130, v114
    v_bfi_b32 v115, s81, v131, v115
    buffer_store_dwordx4 v[112:115], v1, s[44:47], s70 offen offset:0 sc1
    v_fma_f32 v137, v137, s4, v80
    v_fma_f32 v147, v147, s6, v81
    v_fma_f32 v157, v157, s8, v82
    v_fma_f32 v167, v167, s10, v83
    v_fma_f32 v177, v177, s12, v84
    v_fma_f32 v187, v187, s14, v85
    v_fma_f32 v197, v197, s16, v86
    v_fma_f32 v207, v207, s18, v87
    v_cvt_pk_f16_f32 v116, v137, v147
    v_cvt_pk_f16_f32 v117, v157, v167
    v_cvt_pk_f16_f32 v118, v177, v187
    v_cvt_pk_f16_f32 v119, v197, v207
    v_bfi_b32 v116, s81, v128, v116
    v_bfi_b32 v117, s81, v129, v117
    v_bfi_b32 v118, s81, v130, v118
    v_bfi_b32 v119, s81, v131, v119
    buffer_store_dwordx4 v[116:119], v1, s[44:47], s70 offen offset:1024 sc1
    v_fma_f32 v138, v138, s4, v80
    v_fma_f32 v148, v148, s6, v81
    v_fma_f32 v158, v158, s8, v82
    v_fma_f32 v168, v168, s10, v83
    v_fma_f32 v178, v178, s12, v84
    v_fma_f32 v188, v188, s14, v85
    v_fma_f32 v198, v198, s16, v86
    v_fma_f32 v208, v208, s18, v87
    v_cvt_pk_f16_f32 v120, v138, v148
    v_cvt_pk_f16_f32 v121, v158, v168
    v_cvt_pk_f16_f32 v122, v178, v188
    v_cvt_pk_f16_f32 v123, v198, v208
    v_bfi_b32 v120, s81, v128, v120
    v_bfi_b32 v121, s81, v129, v121
    v_bfi_b32 v122, s81, v130, v122
    v_bfi_b32 v123, s81, v131, v123
    buffer_store_dwordx4 v[120:123], v1, s[44:47], s70 offen offset:2048 sc1
    v_fma_f32 v139, v139, s4, v80
    v_fma_f32 v149, v149, s6, v81
    v_fma_f32 v159, v159, s8, v82
    v_fma_f32 v169, v169, s10, v83
    v_fma_f32 v179, v179, s12, v84
    v_fma_f32 v189, v189, s14, v85
    v_fma_f32 v199, v199, s16, v86
    v_fma_f32 v209, v209, s18, v87
    v_cvt_pk_f16_f32 v124, v139, v149
    v_cvt_pk_f16_f32 v125, v159, v169
    v_cvt_pk_f16_f32 v126, v179, v189
    v_cvt_pk_f16_f32 v127, v199, v209
    v_bfi_b32 v124, s81, v128, v124
    v_bfi_b32 v125, s81, v129, v125
    v_bfi_b32 v126, s81, v130, v126
    v_bfi_b32 v127, s81, v131, v127
    buffer_store_dwordx4 v[124:127], v1, s[44:47], s70 offen offset:3072 sc1
    v_fma_f32 v140, v140, s4, v80
    v_fma_f32 v150, v150, s6, v81
    v_fma_f32 v160, v160, s8, v82
    v_fma_f32 v170, v170, s10, v83
    v_fma_f32 v180, v180, s12, v84
    v_fma_f32 v190, v190, s14, v85
    v_fma_f32 v200, v200, s16, v86
    v_fma_f32 v210, v210, s18, v87
    v_cvt_pk_f16_f32 v112, v140, v150
    v_cvt_pk_f16_f32 v113, v160, v170
    v_cvt_pk_f16_f32 v114, v180, v190
    v_cvt_pk_f16_f32 v115, v200, v210
    v_bfi_b32 v112, s81, v128, v112
    v_bfi_b32 v113, s81, v129, v113
    v_bfi_b32 v114, s81, v130, v114
    v_bfi_b32 v115, s81, v131, v115
    s_add_u32 s70, s70, 4096
    buffer_store_dwordx4 v[112:115], v1, s[44:47], s70 offen offset:0 sc1
    v_fma_f32 v141, v141, s4, v80
    v_fma_f32 v151, v151, s6, v81
    v_fma_f32 v161, v161, s8, v82
    v_fma_f32 v171, v171, s10, v83
    v_fma_f32 v181, v181, s12, v84
    v_fma_f32 v191, v191, s14, v85
    v_fma_f32 v201, v201, s16, v86
    v_fma_f32 v211, v211, s18, v87
    v_cvt_pk_f16_f32 v116, v141, v151
    v_cvt_pk_f16_f32 v117, v161, v171
    v_cvt_pk_f16_f32 v118, v181, v191
    v_cvt_pk_f16_f32 v119, v201, v211
    v_bfi_b32 v116, s81, v128, v116
    v_bfi_b32 v117, s81, v129, v117
    v_bfi_b32 v118, s81, v130, v118
    v_bfi_b32 v119, s81, v131, v119
    buffer_store_dwordx4 v[116:119], v1, s[44:47], s70 offen offset:1024 sc1
    v_fma_f32 v142, v142, s4, v80
    v_fma_f32 v152, v152, s6, v81
    v_fma_f32 v162, v162, s8, v82
    v_fma_f32 v172, v172, s10, v83
    v_fma_f32 v182, v182, s12, v84
    v_fma_f32 v192, v192, s14, v85
    v_fma_f32 v202, v202, s16, v86
    v_fma_f32 v212, v212, s18, v87
    v_cvt_pk_f16_f32 v120, v142, v152
    v_cvt_pk_f16_f32 v121, v162, v172
    v_cvt_pk_f16_f32 v122, v182, v192
    v_cvt_pk_f16_f32 v123, v202, v212
    v_bfi_b32 v120, s81, v128, v120
    v_bfi_b32 v121, s81, v129, v121
    v_bfi_b32 v122, s81, v130, v122
    v_bfi_b32 v123, s81, v131, v123
    buffer_store_dwordx4 v[120:123], v1, s[44:47], s70 offen offset:2048 sc1
    v_fma_f32 v143, v143, s4, v80
    v_fma_f32 v153, v153, s6, v81
    v_fma_f32 v163, v163, s8, v82
    v_fma_f32 v173, v173, s10, v83
    v_fma_f32 v183, v183, s12, v84
    v_fma_f32 v193, v193, s14, v85
    v_fma_f32 v203, v203, s16, v86
    v_fma_f32 v213, v213, s18, v87
    v_cvt_pk_f16_f32 v124, v143, v153
    v_cvt_pk_f16_f32 v125, v163, v173
    v_cvt_pk_f16_f32 v126, v183, v193
    v_cvt_pk_f16_f32 v127, v203, v213
    v_bfi_b32 v124, s81, v128, v124
    v_bfi_b32 v125, s81, v129, v125
    v_bfi_b32 v126, s81, v130, v126
    v_bfi_b32 v127, s81, v131, v127
    buffer_store_dwordx4 v[124:127], v1, s[44:47], s70 offen offset:3072 sc1
    v_fma_f32 v144, v144, s4, v80
    v_fma_f32 v154, v154, s6, v81
    v_fma_f32 v164, v164, s8, v82
    v_fma_f32 v174, v174, s10, v83
    v_fma_f32 v184, v184, s12, v84
    v_fma_f32 v194, v194, s14, v85
    v_fma_f32 v204, v204, s16, v86
    v_fma_f32 v214, v214, s18, v87
    v_cvt_pk_f16_f32 v112, v144, v154
    v_cvt_pk_f16_f32 v113, v164, v174
    v_cvt_pk_f16_f32 v114, v184, v194
    v_cvt_pk_f16_f32 v115, v204, v214
    v_bfi_b32 v112, s81, v128, v112
    v_bfi_b32 v113, s81, v129, v113
    v_bfi_b32 v114, s81, v130, v114
    v_bfi_b32 v115, s81, v131, v115
    s_add_u32 s70, s70, 4096
    buffer_store_dwordx4 v[112:115], v1, s[44:47], s70 offen offset:0 sc1
    v_fma_f32 v145, v145, s4, v80
    v_fma_f32 v155, v155, s6, v81
    v_fma_f32 v165, v165, s8, v82
    v_fma_f32 v175, v175, s10, v83
    v_fma_f32 v185, v185, s12, v84
    v_fma_f32 v195, v195, s14, v85
    v_fma_f32 v205, v205, s16, v86
    v_fma_f32 v215, v215, s18, v87
    v_cvt_pk_f16_f32 v116, v145, v155
    v_cvt_pk_f16_f32 v117, v165, v175
    v_cvt_pk_f16_f32 v118, v185, v195
    v_cvt_pk_f16_f32 v119, v205, v215
    v_bfi_b32 v116, s81, v128, v116
    v_bfi_b32 v117, s81, v129, v117
    v_bfi_b32 v118, s81, v130, v118
    v_bfi_b32 v119, s81, v131, v119
    buffer_store_dwordx4 v[116:119], v1, s[44:47], s70 offen offset:1024 sc1
    s_and_b32 s72, s69, 7
    v_and_b32 v4, 3, v0
    v_lshrrev_b32 v5, 2, v0
    v_add_u32 v6, s72, v4
    v_lshrrev_b32 v7, 3, v6
    v_lshlrev_b32 v7, 2, v7
    v_sub_u32 v6, v6, v7
    v_lshlrev_b32 v6, 4, v6
    s_movk_i32 s73, 10240
    v_mad_u32_u24 v6, v5, s73, v6
    v_mul_u32_u24 v7, 13344, v4
    s_movk_i32 s73, 272
    v_mad_u32_u24 v7, v5, s73, v7
    s_andn2_b32 s83, s69, 7
    s_lshl_b32 s83, s83, 4
    s_add_u32 s83, s83, 1048576
    s_and_b32 s84, s60, 1
    s_lshl_b32 s84, s84, 5
    s_add_u32 s84, s84, s61
    s_mul_i32 s84, s84, 30720
    s_add_u32 s84, s84, 4194304
    s_setprio 0
    v_mov_b32 v9, 96
    s_mov_b32 s71, 0x200000
.gg_41:
    ds_read_b32 v8, v9
    s_waitcnt lgkmcnt(0)
    v_readfirstlane_b32 s70, v8
    s_nop 0
    s_cmp_lg_u32 s70, 0
    s_cbranch_scc1 .gge_42
    s_sleep 1
    s_sub_u32 s71, s71, 1
    s_cbranch_scc0 .gg_41
.gge_42:
    s_setprio 3
    s_cmp_eq_u32 s68, 0
    s_cbranch_scc1 .nou_43
    s_mov_b32 s71, 0x20000
.pu_44:
    s_mov_b32 s70, s83
    buffer_load_dwordx4 v[136:139], v6, s[44:47], s70 offen sc1
    s_add_u32 s70, s70, 163840
    buffer_load_dwordx4 v[140:143], v6, s[44:47], s70 offen sc1
    s_add_u32 s70, s70, 163840
    buffer_load_dwordx4 v[144:147], v6, s[44:47], s70 offen sc1
    s_add_u32 s70, s70, 163840
    buffer_load_dwordx4 v[148:151], v6, s[44:47], s70 offen sc1
    s_add_u32 s70, s70, 163840
    buffer_load_dwordx4 v[152:155], v6, s[44:47], s70 offen sc1
    s_add_u32 s70, s70, 163840
    buffer_load_dwordx4 v[156:159], v6, s[44:47], s70 offen sc1
    s_add_u32 s70, s70, 163840
    buffer_load_dwordx4 v[160:163], v6, s[44:47], s70 offen sc1
    s_add_u32 s70, s70, 163840
    buffer_load_dwordx4 v[164:167], v6, s[44:47], s70 offen sc1
    s_add_u32 s70, s70, 163840
    buffer_load_dwordx4 v[168:171], v6, s[44:47], s70 offen sc1
    s_add_u32 s70, s70, 163840
    buffer_load_dwordx4 v[172:175], v6, s[44:47], s70 offen sc1
    s_add_u32 s70, s70, 163840
    buffer_load_dwordx4 v[176:179], v6, s[44:47], s70 offen sc1
    s_add_u32 s70, s70, 163840
    buffer_load_dwordx4 v[180:183], v6, s[44:47], s70 offen sc1
    s_add_u32 s70, s70, 163840
    buffer_load_dwordx4 v[184:187], v6, s[44:47], s70 offen sc1
    s_add_u32 s70, s70, 163840
    buffer_load_dwordx4 v[188:191], v6, s[44:47], s70 offen sc1
    s_add_u32 s70, s70, 163840
    buffer_load_dwordx4 v[192:195], v6, s[44:47], s70 offen sc1
    s_add_u32 s70, s70, 163840
    buffer_load_dwordx4 v[196:199], v6, s[44:47], s70 offen sc1
    s_cmp_lg_u32 s71, 0x20000
    s_cbranch_scc1 .pf_46
    s_waitcnt vmcnt(0)
    s_branch .pf_46x
.pf_46:
    s_waitcnt vmcnt(0)
.pf_46x:
    v_mov_b32 v8, 0
    v_xor_b32 v136, v128, v136
    v_xor_b32 v137, v129, v137
    v_xor_b32 v138, v130, v138
    v_xor_b32 v139, v131, v139
    v_or3_b32 v8, v8, v136, v137
    v_or3_b32 v8, v8, v138, v139
    v_xor_b32 v140, v128, v140
    v_xor_b32 v141, v129, v141
    v_xor_b32 v142, v130, v142
    v_xor_b32 v143, v131, v143
    v_or3_b32 v8, v8, v140, v141
    v_or3_b32 v8, v8, v142, v143
    v_xor_b32 v144, v128, v144
    v_xor_b32 v145, v129, v145
    v_xor_b32 v146, v130, v146
    v_xor_b32 v147, v131, v147
    v_or3_b32 v8, v8, v144, v145
    v_or3_b32 v8, v8, v146, v147
    v_xor_b32 v148, v128, v148
    v_xor_b32 v149, v129, v149
    v_xor_b32 v150, v130, v150
    v_xor_b32 v151, v131, v151
    v_or3_b32 v8, v8, v148, v149
    v_or3_b32 v8, v8, v150, v151
    v_xor_b32 v152, v128, v152
    v_xor_b32 v153, v129, v153
    v_xor_b32 v154, v130, v154
    v_xor_b32 v155, v131, v155
    v_or3_b32 v8, v8, v152, v153
    v_or3_b32 v8, v8, v154, v155
    v_xor_b32 v156, v128, v156
    v_xor_b32 v157, v129, v157
    v_xor_b32 v158, v130, v158
    v_xor_b32 v159, v131, v159
    v_or3_b32 v8, v8, v156, v157
    v_or3_b32 v8, v8, v158, v159
    v_xor_b32 v160, v128, v160
    v_xor_b32 v161, v129, v161
    v_xor_b32 v162, v130, v162
    v_xor_b32 v163, v131, v163
    v_or3_b32 v8, v8, v160, v161
    v_or3_b32 v8, v8, v162, v163
    v_xor_b32 v164, v128, v164
    v_xor_b32 v165, v129, v165
    v_xor_b32 v166, v130, v166
    v_xor_b32 v167, v131, v167
    v_or3_b32 v8, v8, v164, v165
    v_or3_b32 v8, v8, v166, v167
    v_xor_b32 v168, v128, v168
    v_xor_b32 v169, v129, v169
    v_xor_b32 v170, v130, v170
    v_xor_b32 v171, v131, v171
    v_or3_b32 v8, v8, v168, v169
    v_or3_b32 v8, v8, v170, v171
    v_xor_b32 v172, v128, v172
    v_xor_b32 v173, v129, v173
    v_xor_b32 v174, v130, v174
    v_xor_b32 v175, v131, v175
    v_or3_b32 v8, v8, v172, v173
    v_or3_b32 v8, v8, v174, v175
    v_xor_b32 v176, v128, v176
    v_xor_b32 v177, v129, v177
    v_xor_b32 v178, v130, v178
    v_xor_b32 v179, v131, v179
    v_or3_b32 v8, v8, v176, v177
    v_or3_b32 v8, v8, v178, v179
    v_xor_b32 v180, v128, v180
    v_xor_b32 v181, v129, v181
    v_xor_b32 v182, v130, v182
    v_xor_b32 v183, v131, v183
    v_or3_b32 v8, v8, v180, v181
    v_or3_b32 v8, v8, v182, v183
    v_xor_b32 v184, v128, v184
    v_xor_b32 v185, v129, v185
    v_xor_b32 v186, v130, v186
    v_xor_b32 v187, v131, v187
    v_or3_b32 v8, v8, v184, v185
    v_or3_b32 v8, v8, v186, v187
    v_xor_b32 v188, v128, v188
    v_xor_b32 v189, v129, v189
    v_xor_b32 v190, v130, v190
    v_xor_b32 v191, v131, v191
    v_or3_b32 v8, v8, v188, v189
    v_or3_b32 v8, v8, v190, v191
    v_xor_b32 v192, v128, v192
    v_xor_b32 v193, v129, v193
    v_xor_b32 v194, v130, v194
    v_xor_b32 v195, v131, v195
    v_or3_b32 v8, v8, v192, v193
    v_or3_b32 v8, v8, v194, v195
    v_xor_b32 v196, v128, v196
    v_xor_b32 v197, v129, v197
    v_xor_b32 v198, v130, v198
    v_xor_b32 v199, v131, v199
    v_or3_b32 v8, v8, v196, v197
    v_or3_b32 v8, v8, v198, v199
    v_and_b32 v8, s81, v8
    s_nop 1
    v_or_b32_dpp v8, v8, v8 quad_perm:[1,0,3,2] row_mask:0xf bank_mask:0xf
    s_nop 1
    v_or_b32_dpp v8, v8, v8 quad_perm:[2,3,0,1] row_mask:0xf bank_mask:0xf
    v_cmp_ne_u32 vcc, 0, v8
    s_cbranch_vccz .pue_45
    s_mov_b64 exec, vcc
    s_sleep 4
    s_sub_u32 s71, s71, 1
    s_cbranch_scc0 .pu_44
.pue_45:
    s_mov_b64 exec, -1
    v_lshlrev_b32 v40, 16, v136
    v_alignbyte_b32 v41, v137, v136, 2
    v_alignbyte_b32 v42, v138, v137, 2
    v_alignbyte_b32 v43, v139, v138, 2
    v_alignbyte_b32 v44, v140, v139, 2
    v_alignbyte_b32 v45, v141, v140, 2
    v_alignbyte_b32 v46, v142, v141, 2
    v_alignbyte_b32 v47, v143, v142, 2
    v_alignbyte_b32 v48, v144, v143, 2
    v_alignbyte_b32 v49, v145, v144, 2
    v_alignbyte_b32 v50, v146, v145, 2
    v_alignbyte_b32 v51, v147, v146, 2
    v_alignbyte_b32 v52, v148, v147, 2
    v_alignbyte_b32 v53, v149, v148, 2
    v_alignbyte_b32 v54, v150, v149, 2
    v_alignbyte_b32 v55, v151, v150, 2
    v_alignbyte_b32 v56, v152, v151, 2
    v_alignbyte_b32 v57, v153, v152, 2
    v_alignbyte_b32 v58, v154, v153, 2
    v_alignbyte_b32 v59, v155, v154, 2
    v_alignbyte_b32 v60, v156, v155, 2
    v_alignbyte_b32 v61, v157, v156, 2
    v_alignbyte_b32 v62, v158, v157, 2
    v_alignbyte_b32 v63, v159, v158, 2
    v_alignbyte_b32 v64, v160, v159, 2
    v_alignbyte_b32 v65, v161, v160, 2
    v_alignbyte_b32 v66, v162, v161, 2
    v_alignbyte_b32 v67, v163, v162, 2
    v_alignbyte_b32 v68, v164, v163, 2
    v_alignbyte_b32 v69, v165, v164, 2
    v_alignbyte_b32 v70, v166, v165, 2
    v_alignbyte_b32 v71, v167, v166, 2
    v_alignbyte_b32 v72, v168, v167, 2
    v_alignbyte_b32 v73, v169, v168, 2
    v_alignbyte_b32 v74, v170, v169, 2
    v_alignbyte_b32 v75, v171, v170, 2
    v_alignbyte_b32 v76, v172, v171, 2
    v_alignbyte_b32 v77, v173, v172, 2
    v_alignbyte_b32 v78, v174, v173, 2
    v_alignbyte_b32 v79, v175, v174, 2
    v_alignbyte_b32 v80, v176, v175, 2
    v_alignbyte_b32 v81, v177, v176, 2
    v_alignbyte_b32 v82, v178, v177, 2
    v_alignbyte_b32 v83, v179, v178, 2
    v_alignbyte_b32 v84, v180, v179, 2
    v_alignbyte_b32 v85, v181, v180, 2
    v_alignbyte_b32 v86, v182, v181, 2
    v_alignbyte_b32 v87, v183, v182, 2
    v_alignbyte_b32 v88, v184, v183, 2
    v_alignbyte_b32 v89, v185, v184, 2
    v_alignbyte_b32 v90, v186, v185, 2
    v_alignbyte_b32 v91, v187, v186, 2
    v_alignbyte_b32 v92, v188, v187, 2
    v_alignbyte_b32 v93, v189, v188, 2
    v_alignbyte_b32 v94, v190, v189, 2
    v_alignbyte_b32 v95, v191, v190, 2
    v_alignbyte_b32 v96, v192, v191, 2
    v_alignbyte_b32 v97, v193, v192, 2
    v_alignbyte_b32 v98, v194, v193, 2
    v_alignbyte_b32 v99, v195, v194, 2
    v_alignbyte_b32 v100, v196, v195, 2
    v_alignbyte_b32 v101, v197, v196, 2
    v_alignbyte_b32 v102, v198, v197, 2
    v_alignbyte_b32 v103, v199, v198, 2
    v_mov_b32 v9, 0
    s_mov_b32 s71, 0x200000
.wg_47:
    ds_read_b32 v8, v9
    s_waitcnt lgkmcnt(0)
    v_readfirstlane_b32 s70, v8
    s_nop 0
    s_cmp_ge_u32 s70, 11
    s_cbranch_scc1 .wge_48
    s_sleep 1
    s_sub_u32 s71, s71, 1
    s_cbranch_scc0 .wg_47
.wge_48:
    v_and_b32 v9, 3, v0
    v_cmp_gt_u32 vcc, s68, v9
    v_lshlrev_b32 v9, 2, v9
    s_mov_b64 s[70:71], vcc
    s_mov_b32 s87, 0x200000
.kd_49:
    ds_read_b32 v8, v9 offset:480
    s_waitcnt lgkmcnt(0)
    v_cmp_eq_u32 vcc, 0, v8
    s_nop 0
    s_and_b64 vcc, vcc, s[70:71]
    s_cbranch_scc0 .kde_50
    s_sleep 1
    s_sub_u32 s87, s87, 1
    s_cbranch_scc0 .kd_49
.kde_50:
    v_cmp_gt_u32 vcc, s68, v4
    s_nop 0
    s_mov_b64 exec, vcc
    ds_write_b128 v7, v[136:139] offset:4864
    ds_write_b128 v7, v[40:43] offset:512
    ds_write_b128 v7, v[140:143] offset:4880
    ds_write_b128 v7, v[44:47] offset:528
    ds_write_b128 v7, v[144:147] offset:4896
    ds_write_b128 v7, v[48:51] offset:544
    ds_write_b128 v7, v[148:151] offset:4912
    ds_write_b128 v7, v[52:55] offset:560
    ds_write_b128 v7, v[152:155] offset:4928
    ds_write_b128 v7, v[56:59] offset:576
    ds_write_b128 v7, v[156:159] offset:4944
    ds_write_b128 v7, v[60:63] offset:592
    ds_write_b128 v7, v[160:163] offset:4960
    ds_write_b128 v7, v[64:67] offset:608
    ds_write_b128 v7, v[164:167] offset:4976
    ds_write_b128 v7, v[68:71] offset:624
    ds_write_b128 v7, v[168:171] offset:4992
    ds_write_b128 v7, v[72:75] offset:640
    ds_write_b128 v7, v[172:175] offset:5008
    ds_write_b128 v7, v[76:79] offset:656
    ds_write_b128 v7, v[176:179] offset:5024
    ds_write_b128 v7, v[80:83] offset:672
    ds_write_b128 v7, v[180:183] offset:5040
    ds_write_b128 v7, v[84:87] offset:688
    ds_write_b128 v7, v[184:187] offset:5056
    ds_write_b128 v7, v[88:91] offset:704
    ds_write_b128 v7, v[188:191] offset:5072
    ds_write_b128 v7, v[92:95] offset:720
    ds_write_b128 v7, v[192:195] offset:5088
    ds_write_b128 v7, v[96:99] offset:736
    ds_write_b128 v7, v[196:199] offset:5104
    ds_write_b128 v7, v[100:103] offset:752
    s_mov_b64 exec, -1
    s_cmp_lg_u32 s2, 0
    s_cbranch_scc1 .nou_43
    s_mov_b64 exec, 1
    v_mov_b32 v4, s86
    buffer_store_dword v4, off, s[44:47], 0 sc1
    s_mov_b64 exec, -1
.nou_43:
    v_mov_b32 v4, 1
    v_mov_b32 v5, 452
    ds_write_b32 v5, v4
    s_setprio 0
    s_lshl_b32 s83, s65, 5
    s_add_u32 s83, s83, s64
    s_mul_i32 s83, s83, 10240
    s_add_u32 s83, s83, 12582912
    s_lshl_b32 s81, s81, 13
    v_lshlrev_b32 v128, 13, v128
    v_lshlrev_b32 v129, 13, v129
    v_lshlrev_b32 v130, 13, v130
    v_lshlrev_b32 v131, 13, v131
    v_lshrrev_b32 v6, 5, v0
    v_lshl_add_u32 v6, v6, 4, v1
    v_mov_b32 v5, 16
    s_mov_b32 s71, 0x200000
.g2_51:
    ds_read_b32 v4, v5
    s_waitcnt lgkmcnt(0)
    v_readfirstlane_b32 s70, v4
    s_nop 0
    s_cmp_ge_u32 s70, 13
    s_cbranch_scc1 .g2e_52
    s_sleep 4
    s_sub_u32 s71, s71, 1
    s_cbranch_scc0 .g2_51
.g2e_52:
    s_min_u32 s72, s68, 1
    v_mov_b32 v5, 464
    s_mov_b32 s71, 0x200000
.sd_53:
    ds_read_b32 v4, v5
    s_waitcnt lgkmcnt(0)
    v_readfirstlane_b32 s70, v4
    s_nop 0
    s_cmp_ge_u32 s70, s72
    s_cbranch_scc1 .sde_54
    s_sleep 4
    s_sub_u32 s71, s71, 1
    s_cbranch_scc0 .sd_53
.sde_54:
    s_setprio 3
    s_mov_b32 s71, 0x20000
.ps_55:
    s_mov_b32 s70, s83
    buffer_load_dwordx4 v[8:11], v1, s[44:47], s70 offen offset:0 sc1
    buffer_load_dwordx4 v[12:15], v1, s[44:47], s70 offen offset:1024 sc1
    buffer_load_dwordx4 v[16:19], v1, s[44:47], s70 offen offset:2048 sc1
    buffer_load_dwordx4 v[20:23], v1, s[44:47], s70 offen offset:3072 sc1
    s_add_u32 s70, s70, 4096
    buffer_load_dwordx4 v[24:27], v1, s[44:47], s70 offen offset:0 sc1
    buffer_load_dwordx4 v[28:31], v1, s[44:47], s70 offen offset:1024 sc1
    buffer_load_dwordx4 v[32:35], v1, s[44:47], s70 offen offset:2048 sc1
    buffer_load_dwordx4 v[36:39], v1, s[44:47], s70 offen offset:3072 sc1
    s_add_u32 s70, s70, 4096
    buffer_load_dwordx4 v[40:43], v1, s[44:47], s70 offen offset:0 sc1
    buffer_load_dwordx4 v[44:47], v1, s[44:47], s70 offen offset:1024 sc1
    v_mov_b32 v4, 0
    s_waitcnt vmcnt(9)
    v_xor_b32 v8, v128, v8
    v_xor_b32 v9, v129, v9
    v_xor_b32 v10, v130, v10
    v_xor_b32 v11, v131, v11
    ds_write_b128 v6, v[8:11] offset:512
    v_or3_b32 v4, v4, v8, v9
    v_or3_b32 v4, v4, v10, v11
    s_waitcnt vmcnt(8)
    v_xor_b32 v12, v128, v12
    v_xor_b32 v13, v129, v13
    v_xor_b32 v14, v130, v14
    v_xor_b32_e64 v15, v131, v15
    ds_write_b128 v6, v[12:15] offset:1568
    v_or3_b32 v4, v4, v12, v13
    v_or3_b32 v4, v4, v14, v15
    s_waitcnt vmcnt(7)
    v_xor_b32 v16, v128, v16
    v_xor_b32 v17, v129, v17
    v_xor_b32 v18, v130, v18
    v_xor_b32_e64 v19, v131, v19
    ds_write_b128 v6, v[16:19] offset:2624
    v_or3_b32 v4, v4, v16, v17
    v_or3_b32 v4, v4, v18, v19
    s_waitcnt vmcnt(6)
    v_xor_b32 v20, v128, v20
    v_xor_b32 v21, v129, v21
    v_xor_b32 v22, v130, v22
    v_xor_b32_e64 v23, v131, v23
    ds_write_b128 v6, v[20:23] offset:3680
    v_or3_b32 v4, v4, v20, v21
    v_or3_b32 v4, v4, v22, v23
    s_waitcnt vmcnt(5)
    v_xor_b32 v24, v128, v24
    v_xor_b32 v25, v129, v25
    v_xor_b32 v26, v130, v26
    v_xor_b32_e64 v27, v131, v27
    ds_write_b128 v6, v[24:27] offset:4736
    v_or3_b32 v4, v4, v24, v25
    v_or3_b32 v4, v4, v26, v27
    s_waitcnt vmcnt(4)
    v_xor_b32 v28, v128, v28
    v_xor_b32 v29, v129, v29
    v_xor_b32 v30, v130, v30
    v_xor_b32_e64 v31, v131, v31
    ds_write_b128 v6, v[28:31] offset:5792
    v_or3_b32 v4, v4, v28, v29
    v_or3_b32 v4, v4, v30, v31
    s_waitcnt vmcnt(3)
    v_xor_b32 v32, v128, v32
    v_xor_b32 v33, v129, v33
    v_xor_b32 v34, v130, v34
    v_xor_b32_e64 v35, v131, v35
    ds_write_b128 v6, v[32:35] offset:6848
    v_or3_b32 v4, v4, v32, v33
    v_or3_b32 v4, v4, v34, v35
    s_waitcnt vmcnt(2)
    v_xor_b32 v36, v128, v36
    v_xor_b32 v37, v129, v37
    v_xor_b32 v38, v130, v38
    v_xor_b32_e64 v39, v131, v39
    ds_write_b128 v6, v[36:39] offset:7904
    v_or3_b32 v4, v4, v36, v37
    v_or3_b32 v4, v4, v38, v39
    s_waitcnt vmcnt(1)
    v_xor_b32 v40, v128, v40
    v_xor_b32 v41, v129, v41
    v_xor_b32 v42, v130, v42
    v_xor_b32_e64 v43, v131, v43
    ds_write_b128 v6, v[40:43] offset:8960
    v_or3_b32 v4, v4, v40, v41
    v_or3_b32 v4, v4, v42, v43
    s_waitcnt vmcnt(0)
    v_xor_b32 v44, v128, v44
    v_xor_b32 v45, v129, v45
    v_xor_b32 v46, v130, v46
    v_xor_b32_e64 v47, v131, v47
    ds_write_b128 v6, v[44:47] offset:10016
    v_or3_b32 v4, v4, v44, v45
    v_or3_b32 v4, v4, v46, v47
    v_and_b32 v4, s81, v4
    s_nop 1
    v_or_b32_dpp v4, v4, v4 quad_perm:[1,0,3,2] row_mask:0xf bank_mask:0xf
    s_nop 1
    v_or_b32_dpp v4, v4, v4 quad_perm:[2,3,0,1] row_mask:0xf bank_mask:0xf
    s_nop 1
    v_or_b32_dpp v4, v4, v4 row_half_mirror row_mask:0xf bank_mask:0xf
    v_cmp_ne_u32 vcc, 0, v4
    s_cbranch_vccz .pse_56
    s_mov_b64 exec, vcc
    s_sleep 4
    s_sub_u32 s71, s71, 1
    s_cbranch_scc0 .ps_55
.pse_56:
    s_mov_b64 exec, -1
    v_mov_b32 v4, 1
    v_mov_b32 v5, 456
    ds_write_b32 v5, v4
    s_endpgm
.Lssm:
    s_cmp_ge_u32 s72, s68
    s_cbranch_scc1 .Lend
    s_mov_b64 s[44:45], s[36:37]
    s_mov_b32 s46, 268435456
    s_mov_b32 s47, 0x20000
    s_setprio 1
    s_mul_i32 s78, s72, 13344
    s_add_u32 s78, s78, 512
    s_add_u32 s79, s78, 8704
    v_and_b32 v30, 15, v0
    v_lshlrev_b32 v31, 2, v30
    v_lshrrev_b32 v32, 4, v0
    v_lshlrev_b32 v32, 3, v32
    v_sub_u32 v32, 248, v32
    v_add_u32 v32, s79, v32
    s_movk_i32 s70, 288
    v_and_b32 v33, 12, v31
    v_lshrrev_b32 v34, 2, v30
    v_add_u32 v33, v33, v34
    v_mad_u32_u24 v1, v33, s70, v32
    s_mov_b32 s80, 0xea62b730
    s_mov_b32 s81, 0xb630b630
    v_lshrrev_b64 v[34:35], v31, s[80:81]
    v_and_b32_e64 v36, 15, v34
    s_mov_b32 s80, 0xea62d951
    s_mov_b32 s81, 0xda52da52
    v_lshrrev_b64 v[34:35], v31, s[80:81]
    v_and_b32_e64 v37, 15, v34
    s_mov_b32 s80, 0x11111111
    s_mov_b32 s81, 0x33332222
    v_lshrrev_b64 v[34:35], v31, s[80:81]
    v_and_b32 v38, 15, v34
    v_lshlrev_b32 v38, 5, v38
    v_sub_u32_e64 v38, v32, v38
    v_mad_u32_u24 v4, v36, s70, v38
    v_mad_u32_u24 v5, v37, s70, v38
    s_mov_b32 s80, 0x50c50c50
    s_mov_b32 s81, 0xeeefc50c
    v_lshrrev_b64 v[34:35], v31, s[80:81]
    v_and_b32_e64 v36, 15, v34
    s_mov_b32 s80, 0xb4fb4fb4
    s_mov_b32 s81, 0xfffffb4f
    v_lshrrev_b64 v[34:35], v31, s[80:81]
    v_and_b32_e64 v37, 15, v34
    s_mov_b32 s80, 0x66555444
    s_mov_b32 s81, 0x33217776
    v_lshrrev_b64 v[34:35], v31, s[80:81]
    v_and_b32 v38, 15, v34
    v_lshlrev_b32 v38, 5, v38
    v_sub_u32_e64 v38, v32, v38
    v_mad_u32_u24 v6, v36, s70, v38
    v_mad_u32_u24 v7, v37, s70, v38
    s_mul_i32 s86, s72, 17248
    s_add_u32 s86, s86, 512
    v_and_b32 v36, 16, v0
    v_and_b32 v33, 32, v0
    v_lshlrev_b32 v33, 1, v33
    v_lshl_add_u32 v36, v36, 3, v33
    v_add_u32 v33, s86, v36
    v_add_u32 v36, 512, v36
    s_movk_i32 s70, 784
    s_mov_b32 s80, 0x43214321
    s_mov_b32 s81, 0x43214321
    v_lshrrev_b64 v[34:35], v31, s[80:81]
    v_and_b32 v34, 15, v34
    v_mad_u32_u24 v240, v34, s70, v33
    s_mov_b32 s80, 0x55550000
    s_mov_b32 s81, 0x77776666
    v_lshrrev_b64 v[34:35], v31, s[80:81]
    v_and_b32 v34, 15, v34
    v_cmp_eq_u32 vcc, 0, v34
    v_mad_u32_u24 v241, v34, s70, v33
    s_nop 0
    v_cndmask_b32 v241, v241, v36, vcc
    s_mov_b32 s80, 0x88880000
    s_mov_b32 s81, 0xaaaa9999
    v_lshrrev_b64 v[34:35], v31, s[80:81]
    v_and_b32 v34, 15, v34
    v_cmp_eq_u32 vcc, 0, v34
    v_mad_u32_u24 v242, v34, s70, v33
    s_nop 0
    v_cndmask_b32 v242, v242, v36, vcc
    s_mov_b32 s80, 0x77770000
    s_mov_b32 s81, 0x22221111
    v_lshrrev_b64 v[34:35], v31, s[80:81]
    v_and_b32 v34, 15, v34
    v_add_u32 v34, 15, v34
    v_mad_u32_u24 v244, v34, s70, v33
    s_mov_b32 s80, 0xdcb0dcb0
    s_mov_b32 s81, 0xdcb0dcb0
    v_lshrrev_b64 v[34:35], v31, s[80:81]
    v_and_b32 v34, 15, v34
    v_cmp_eq_u32 vcc, 0, v34
    v_mad_u32_u24 v245, v34, s70, v33
    s_nop 0
    v_cndmask_b32 v245, v245, v36, vcc
    s_mov_b32 s80, 0x55444333
    s_mov_b32 s81, 0x22106665
    v_lshrrev_b64 v[34:35], v31, s[80:81]
    v_and_b32 v34, 15, v34
    v_add_u32 v34, 15, v34
    v_mad_u32_u24 v246, v34, s70, v33
    s_mov_b32 s80, 0xc0ec0ec0
    s_mov_b32 s81, 0xeeeeec0e
    v_lshrrev_b64 v[34:35], v31, s[80:81]
    v_and_b32 v34, 15, v34
    v_cmp_eq_u32 vcc, 0, v34
    v_mad_u32_u24 v247, v34, s70, v33
    s_nop 0
    v_cndmask_b32 v247, v247, v36, vcc
    s_mov_b32 m0, 0
    v_mov_b32 v34, 0x3c00
    ds_write_addtid_b32 v34 offset:512
    ds_write_addtid_b32 v34 offset:768
    ds_write_addtid_b32 v34 offset:1024
    s_mov_b32 m0, s86
    s_waitcnt vmcnt(0) lgkmcnt(0)
    s_bitcmp1_b32 s76, 0
    s_cselect_b32 s70, 0, 16
    s_lshl_b32 s84, s84, s70
    s_lshl_b32 s85, s85, s70
    s_mov_b32 s71, 0xffff0000
    s_and_b32 s84, s84, s71
    s_and_b32 s85, s85, s71
    v_mov_b32 v26, s84
    v_mov_b32 v27, s85
    v_mul_f32 v26, 0x3fb8aa3b, v26
    v_exp_f32 v26, v26
    v_and_b32 v14, s71, v8
    v_lshlrev_b32 v8, 16, v8
    v_lshlrev_b32 v20, 16, v20
    v_and_b32 v15, s71, v9
    v_lshlrev_b32 v9, 16, v9
    v_lshlrev_b32 v21, 16, v21
    v_and_b32 v16, s71, v10
    v_lshlrev_b32 v10, 16, v10
    v_lshlrev_b32 v22, 16, v22
    v_and_b32 v17, s71, v11
    v_lshlrev_b32 v11, 16, v11
    v_lshlrev_b32 v23, 16, v23
    v_and_b32 v18, s71, v12
    v_lshlrev_b32 v12, 16, v12
    v_lshlrev_b32 v24, 16, v24
    v_and_b32 v19, s71, v13
    v_lshlrev_b32 v13, 16, v13
    v_lshlrev_b32 v25, 16, v25
    v_cvt_pk_bf16_f32 v26, v26, v26
    v_and_b32 v26, s71, v26
    v_mul_f32 v40, v12, v10
    v_mul_f32 v41, v12, v11
    v_fma_f32 v40, -v13, v11, v40
    v_fmac_f32 v41, v13, v10
    v_mul_f32 v42, v18, v16
    v_mul_f32 v43, v18, v17
    v_fma_f32 v42, -v19, v17, v42
    v_fmac_f32 v43, v19, v16
    v_mul_f32 v44, v24, v22
    v_mul_f32 v45, v24, v23
    v_fma_f32 v44, -v25, v23, v44
    v_fmac_f32 v45, v25, v22
    v_mul_f32 v30, 0x3fb8aa3b, v26
    v_mul_f32 v31, 0x3e22f983, v26
    v_mul_f32 v8, v8, v30
    v_mul_f32 v9, v9, v31
    v_add_f32 v32, abs(v40), abs(v41)
    v_mul_f32 v14, v14, v30
    v_mul_f32 v15, v15, v31
    v_add_f32 v33, abs(v42), abs(v43)
    v_mul_f32 v20, v20, v30
    v_mul_f32 v21, v21, v31
    v_add_f32 v34, abs(v44), abs(v45)
    v_rcp_f32 v35, v26
    v_max3_f32 v32, v32, v33, v34
    v_mul_f32_e64 v27, v27, v35
    v_mul_f32 v33, 0x3c000000, v27
    s_mov_b32 s70, 0x0da24260
    v_max3_f32 v32, v32, abs(v33), s70
    s_nop 1
    v_max_f32_dpp v32, v32, v32 row_ror:8 row_mask:0xf bank_mask:0xf
    s_nop 1
    v_max_f32_dpp v32, v32, v32 row_ror:4 row_mask:0xf bank_mask:0xf
    s_nop 1
    v_max_f32_dpp v32, v32, v32 row_ror:2 row_mask:0xf bank_mask:0xf
    s_nop 1
    v_max_f32_dpp v32, v32, v32 row_ror:1 row_mask:0xf bank_mask:0xf
    v_mov_b32 v33, v32
    s_nop 1
    v_permlane16_swap_b32 v32, v33
    v_max_f32 v32, v32, v33
    v_mov_b32 v33, v32
    s_nop 1
    v_permlane32_swap_b32 v32, v33
    v_max_f32 v32, v32, v33
    v_frexp_exp_i32_f32 v32, v32
    v_sub_u32 v33, 7, v32
    v_subrev_u32 v32, 94, v32
    v_ldexp_f32 v33, 1.0, v33
    v_ldexp_f32 v32, v26, v32
    v_mul_f32 v10, v40, v33
    v_mul_f32 v11, v41, v33
    v_mul_f32 v16, v42, v33
    v_mul_f32 v17, v43, v33
    v_mul_f32 v22, v44, v33
    v_mul_f32 v23, v45, v33
    v_readfirstlane_b32 s82, v32
    v_mul_f32 v27, v27, v33
    v_cmp_eq_u32 vcc, 0, v0
    v_mov_b32 v29, 0
    v_mov_b32 v30, 0
    v_mov_b32 v31, 0
    v_mov_b32 v32, 0
    v_mov_b32 v33, 0
    v_mov_b32 v34, 0
    v_mov_b32 v35, 0
    v_mov_b32 v36, 0
    v_mov_b32 v37, 0
    v_mov_b32 v38, 0
    v_mov_b32 v39, 0
    v_cndmask_b32 v28, 0, v27, vcc
    v_and_b32 v26, 3, v0
    v_lshlrev_b32 v26, 4, v26
    v_mov_b32 v2, v240
    v_mov_b32 v3, v241
    v_mov_b32 v12, v242
    v_mov_b32 v13, v244
    v_mov_b32 v18, v245
    v_mov_b32 v19, v246
    v_mov_b32 v24, v247
    v_exp_f32 v84, v8
    v_fract_f32 v85, v9
    v_cos_f32 v54, v85
    v_sin_f32 v55, v85
    v_mul_f32 v54, v54, v84
    v_mul_f32 v55, v55, v84
    v_mul_f32 v84, 0x42800000, v8
    v_mul_f32 v85, 0x42800000, v9
    v_exp_f32 v84, v84
    v_fract_f32 v85, v85
    v_cos_f32 v48, v85
    v_sin_f32 v49, v85
    v_mul_f32 v48, v48, v84
    v_mul_f32 v49, v49, v84
    v_pk_mul_f32 v[56:57], v[54:55], v[54:55] op_sel_hi:[0,1]
    v_pk_fma_f32 v[56:57], v[54:55], v[54:55], v[56:57] op_sel:[1,1,0] op_sel_hi:[1,0,1] neg_lo:[0,1,0]
    v_pk_mul_f32 v[50:51], v[48:49], v[48:49] op_sel_hi:[0,1]
    v_pk_fma_f32 v[50:51], v[48:49], v[48:49], v[50:51] op_sel:[1,1,0] op_sel_hi:[1,0,1] neg_lo:[0,1,0]
    v_pk_mul_f32 v[58:59], v[56:57], v[54:55] op_sel_hi:[0,1]
    v_pk_fma_f32 v[58:59], v[56:57], v[54:55], v[58:59] op_sel:[1,1,0] op_sel_hi:[1,0,1] neg_lo:[0,1,0]
    v_pk_mul_f32 v[60:61], v[56:57], v[56:57] op_sel_hi:[0,1]
    v_pk_fma_f32 v[60:61], v[56:57], v[56:57], v[60:61] op_sel:[1,1,0] op_sel_hi:[1,0,1] neg_lo:[0,1,0]
    v_pk_mul_f32 v[52:53], v[50:51], v[48:49] op_sel_hi:[0,1]
    v_pk_fma_f32 v[52:53], v[50:51], v[48:49], v[52:53] op_sel:[1,1,0] op_sel_hi:[1,0,1] neg_lo:[0,1,0]
    v_pk_mul_f32 v[68:69], v[50:51], v[50:51] op_sel_hi:[0,1]
    v_pk_fma_f32 v[68:69], v[50:51], v[50:51], v[68:69] op_sel:[1,1,0] op_sel_hi:[1,0,1] neg_lo:[0,1,0]
    v_pk_mul_f32 v[62:63], v[60:61], v[60:61] op_sel_hi:[0,1]
    v_pk_fma_f32 v[62:63], v[60:61], v[60:61], v[62:63] op_sel:[1,1,0] op_sel_hi:[1,0,1] neg_lo:[0,1,0]
    v_pk_mul_f32 v[70:71], v[68:69], v[68:69] op_sel_hi:[0,1]
    v_pk_fma_f32 v[70:71], v[68:69], v[68:69], v[70:71] op_sel:[1,1,0] op_sel_hi:[1,0,1] neg_lo:[0,1,0]
    v_pk_mul_f32 v[64:65], v[62:63], v[60:61] op_sel_hi:[0,1]
    v_pk_fma_f32 v[64:65], v[62:63], v[60:61], v[64:65] op_sel:[1,1,0] op_sel_hi:[1,0,1] neg_lo:[0,1,0]
    v_pk_mul_f32 v[66:67], v[62:63], v[62:63] op_sel_hi:[0,1]
    v_pk_fma_f32 v[66:67], v[62:63], v[62:63], v[66:67] op_sel:[1,1,0] op_sel_hi:[1,0,1] neg_lo:[0,1,0]
    v_pk_mul_f32 v[72:73], v[70:71], v[68:69] op_sel_hi:[0,1]
    v_pk_fma_f32 v[72:73], v[70:71], v[68:69], v[72:73] op_sel:[1,1,0] op_sel_hi:[1,0,1] neg_lo:[0,1,0]
    v_pk_mul_f32 v[74:75], v[70:71], v[70:71] op_sel_hi:[0,1]
    v_pk_fma_f32 v[74:75], v[70:71], v[70:71], v[74:75] op_sel:[1,1,0] op_sel_hi:[1,0,1] neg_lo:[0,1,0]
    v_pk_mul_f32 v[42:43], v[10:11], v[66:67] op_sel_hi:[0,1]
    v_pk_fma_f32 v[42:43], v[10:11], v[66:67], v[42:43] op_sel:[1,1,0] op_sel_hi:[1,0,1] neg_lo:[0,1,0]
    v_pk_mul_f32 v[82:83], v[68:69], v[56:57] op_sel_hi:[0,1]
    v_pk_fma_f32 v[82:83], v[68:69], v[56:57], v[82:83] op_sel:[1,1,0] op_sel_hi:[1,0,1] neg_lo:[0,1,0]
    v_pk_mul_f32 v[76:77], v[74:75], v[68:69] op_sel_hi:[0,1]
    v_pk_fma_f32 v[76:77], v[74:75], v[68:69], v[76:77] op_sel:[1,1,0] op_sel_hi:[1,0,1] neg_lo:[0,1,0]
    v_pk_mul_f32 v[44:45], v[42:43], v[66:67] op_sel_hi:[0,1]
    v_pk_fma_f32 v[44:45], v[42:43], v[66:67], v[44:45] op_sel:[1,1,0] op_sel_hi:[1,0,1] neg_lo:[0,1,0]
    v_pk_mul_f32 v[78:79], v[74:75], v[70:71] op_sel_hi:[0,1]
    v_pk_fma_f32 v[78:79], v[74:75], v[70:71], v[78:79] op_sel:[1,1,0] op_sel_hi:[1,0,1] neg_lo:[0,1,0]
    v_pk_mul_f32 v[80:81], v[74:75], v[72:73] op_sel_hi:[0,1]
    v_pk_fma_f32 v[80:81], v[74:75], v[72:73], v[80:81] op_sel:[1,1,0] op_sel_hi:[1,0,1] neg_lo:[0,1,0]
    v_pk_mul_f32 v[46:47], v[44:45], v[66:67] op_sel_hi:[0,1]
    v_pk_fma_f32 v[46:47], v[44:45], v[66:67], v[46:47] op_sel:[1,1,0] op_sel_hi:[1,0,1] neg_lo:[0,1,0]
    v_cvt_pk_f16_f32 v40, v10, v11
    v_cvt_pk_f16_f32 v42, v42, v43
    v_cvt_pk_f16_f32 v44, v44, v45
    v_cvt_pk_f16_f32 v46, v46, v47
    v_cvt_pk_f16_f32 v48, v48, v49
    v_cvt_pk_f16_f32 v50, v50, v51
    v_cvt_pk_f16_f32 v52, v52, v53
    v_cvt_pk_f16_f32 v54, v54, v55
    v_cvt_pk_f16_f32 v56, v56, v57
    v_cvt_pk_f16_f32 v58, v58, v59
    v_cvt_pk_f16_f32 v60, v60, v61
    v_cvt_pk_f16_f32 v62, v62, v63
    v_cvt_pk_f16_f32 v64, v64, v65
    v_cvt_pk_f16_f32 v66, v66, v67
    v_cvt_pk_f16_f32 v68, v68, v69
    v_cvt_pk_f16_f32 v70, v70, v71
    v_cvt_pk_f16_f32 v72, v72, v73
    v_cvt_pk_f16_f32 v74, v74, v75
    v_cvt_pk_f16_f32 v76, v76, v77
    v_cvt_pk_f16_f32 v78, v78, v79
    v_cvt_pk_f16_f32 v80, v80, v81
    v_cvt_pk_f16_f32 v82, v82, v83
    ds_write_addtid_b32 v40 offset:784
    ds_write_addtid_b32 v42 offset:1568
    ds_write_addtid_b32 v44 offset:2352
    ds_write_addtid_b32 v46 offset:3136
    ds_write_addtid_b32 v48 offset:3920
    ds_write_addtid_b32 v50 offset:4704
    ds_write_addtid_b32 v52 offset:5488
    ds_write_addtid_b32 v54 offset:6272
    ds_write_addtid_b32 v56 offset:7056
    ds_write_addtid_b32 v58 offset:7840
    ds_write_addtid_b32 v60 offset:8624
    ds_write_addtid_b32 v62 offset:9408
    ds_write_addtid_b32 v64 offset:10192
    ds_write_addtid_b32 v66 offset:10976
    ds_write_addtid_b32 v68 offset:11760
    ds_write_addtid_b32 v70 offset:12544
    ds_write_addtid_b32 v72 offset:13328
    ds_write_addtid_b32 v74 offset:14112
    ds_write_addtid_b32 v76 offset:14896
    ds_write_addtid_b32 v78 offset:15680
    ds_write_addtid_b32 v80 offset:16464
    ds_write_addtid_b32 v82 offset:17248
    v_exp_f32 v84, v14
    v_fract_f32 v85, v15
    v_cos_f32 v54, v85
    v_sin_f32 v55, v85
    v_mul_f32 v54, v54, v84
    v_mul_f32 v55, v55, v84
    v_mul_f32 v84, 0x42800000, v14
    v_mul_f32 v85, 0x42800000, v15
    v_exp_f32 v84, v84
    v_fract_f32 v85, v85
    v_cos_f32 v48, v85
    v_sin_f32 v49, v85
    v_mul_f32 v48, v48, v84
    v_mul_f32 v49, v49, v84
    v_pk_mul_f32 v[56:57], v[54:55], v[54:55] op_sel_hi:[0,1]
    v_pk_fma_f32 v[56:57], v[54:55], v[54:55], v[56:57] op_sel:[1,1,0] op_sel_hi:[1,0,1] neg_lo:[0,1,0]
    v_pk_mul_f32 v[50:51], v[48:49], v[48:49] op_sel_hi:[0,1]
    v_pk_fma_f32 v[50:51], v[48:49], v[48:49], v[50:51] op_sel:[1,1,0] op_sel_hi:[1,0,1] neg_lo:[0,1,0]
    v_pk_mul_f32 v[58:59], v[56:57], v[54:55] op_sel_hi:[0,1]
    v_pk_fma_f32 v[58:59], v[56:57], v[54:55], v[58:59] op_sel:[1,1,0] op_sel_hi:[1,0,1] neg_lo:[0,1,0]
    v_pk_mul_f32 v[60:61], v[56:57], v[56:57] op_sel_hi:[0,1]
    v_pk_fma_f32 v[60:61], v[56:57], v[56:57], v[60:61] op_sel:[1,1,0] op_sel_hi:[1,0,1] neg_lo:[0,1,0]
    v_pk_mul_f32 v[52:53], v[50:51], v[48:49] op_sel_hi:[0,1]
    v_pk_fma_f32 v[52:53], v[50:51], v[48:49], v[52:53] op_sel:[1,1,0] op_sel_hi:[1,0,1] neg_lo:[0,1,0]
    v_pk_mul_f32 v[68:69], v[50:51], v[50:51] op_sel_hi:[0,1]
    v_pk_fma_f32 v[68:69], v[50:51], v[50:51], v[68:69] op_sel:[1,1,0] op_sel_hi:[1,0,1] neg_lo:[0,1,0]
    v_pk_mul_f32 v[62:63], v[60:61], v[60:61] op_sel_hi:[0,1]
    v_pk_fma_f32 v[62:63], v[60:61], v[60:61], v[62:63] op_sel:[1,1,0] op_sel_hi:[1,0,1] neg_lo:[0,1,0]
    v_pk_mul_f32 v[70:71], v[68:69], v[68:69] op_sel_hi:[0,1]
    v_pk_fma_f32 v[70:71], v[68:69], v[68:69], v[70:71] op_sel:[1,1,0] op_sel_hi:[1,0,1] neg_lo:[0,1,0]
    v_pk_mul_f32 v[64:65], v[62:63], v[60:61] op_sel_hi:[0,1]
    v_pk_fma_f32 v[64:65], v[62:63], v[60:61], v[64:65] op_sel:[1,1,0] op_sel_hi:[1,0,1] neg_lo:[0,1,0]
    v_pk_mul_f32 v[66:67], v[62:63], v[62:63] op_sel_hi:[0,1]
    v_pk_fma_f32 v[66:67], v[62:63], v[62:63], v[66:67] op_sel:[1,1,0] op_sel_hi:[1,0,1] neg_lo:[0,1,0]
    v_pk_mul_f32 v[72:73], v[70:71], v[68:69] op_sel_hi:[0,1]
    v_pk_fma_f32 v[72:73], v[70:71], v[68:69], v[72:73] op_sel:[1,1,0] op_sel_hi:[1,0,1] neg_lo:[0,1,0]
    v_pk_mul_f32 v[74:75], v[70:71], v[70:71] op_sel_hi:[0,1]
    v_pk_fma_f32 v[74:75], v[70:71], v[70:71], v[74:75] op_sel:[1,1,0] op_sel_hi:[1,0,1] neg_lo:[0,1,0]
    v_pk_mul_f32 v[42:43], v[16:17], v[66:67] op_sel_hi:[0,1]
    v_pk_fma_f32 v[42:43], v[16:17], v[66:67], v[42:43] op_sel:[1,1,0] op_sel_hi:[1,0,1] neg_lo:[0,1,0]
    v_pk_mul_f32 v[82:83], v[68:69], v[56:57] op_sel_hi:[0,1]
    v_pk_fma_f32 v[82:83], v[68:69], v[56:57], v[82:83] op_sel:[1,1,0] op_sel_hi:[1,0,1] neg_lo:[0,1,0]
    v_pk_mul_f32 v[76:77], v[74:75], v[68:69] op_sel_hi:[0,1]
    v_pk_fma_f32 v[76:77], v[74:75], v[68:69], v[76:77] op_sel:[1,1,0] op_sel_hi:[1,0,1] neg_lo:[0,1,0]
    v_pk_mul_f32 v[44:45], v[42:43], v[66:67] op_sel_hi:[0,1]
    v_pk_fma_f32 v[44:45], v[42:43], v[66:67], v[44:45] op_sel:[1,1,0] op_sel_hi:[1,0,1] neg_lo:[0,1,0]
    v_pk_mul_f32 v[78:79], v[74:75], v[70:71] op_sel_hi:[0,1]
    v_pk_fma_f32 v[78:79], v[74:75], v[70:71], v[78:79] op_sel:[1,1,0] op_sel_hi:[1,0,1] neg_lo:[0,1,0]
    v_pk_mul_f32 v[80:81], v[74:75], v[72:73] op_sel_hi:[0,1]
    v_pk_fma_f32 v[80:81], v[74:75], v[72:73], v[80:81] op_sel:[1,1,0] op_sel_hi:[1,0,1] neg_lo:[0,1,0]
    v_pk_mul_f32 v[46:47], v[44:45], v[66:67] op_sel_hi:[0,1]
    v_pk_fma_f32 v[46:47], v[44:45], v[66:67], v[46:47] op_sel:[1,1,0] op_sel_hi:[1,0,1] neg_lo:[0,1,0]
    v_cvt_pk_f16_f32 v40, v16, v17
    v_cvt_pk_f16_f32 v42, v42, v43
    v_cvt_pk_f16_f32 v44, v44, v45
    v_cvt_pk_f16_f32 v46, v46, v47
    v_cvt_pk_f16_f32 v48, v48, v49
    v_cvt_pk_f16_f32 v50, v50, v51
    v_cvt_pk_f16_f32 v52, v52, v53
    v_cvt_pk_f16_f32 v54, v54, v55
    v_cvt_pk_f16_f32 v56, v56, v57
    v_cvt_pk_f16_f32 v58, v58, v59
    v_cvt_pk_f16_f32 v60, v60, v61
    v_cvt_pk_f16_f32 v62, v62, v63
    v_cvt_pk_f16_f32 v64, v64, v65
    v_cvt_pk_f16_f32 v66, v66, v67
    v_cvt_pk_f16_f32 v68, v68, v69
    v_cvt_pk_f16_f32 v70, v70, v71
    v_cvt_pk_f16_f32 v72, v72, v73
    v_cvt_pk_f16_f32 v74, v74, v75
    v_cvt_pk_f16_f32 v76, v76, v77
    v_cvt_pk_f16_f32 v78, v78, v79
    v_cvt_pk_f16_f32 v80, v80, v81
    v_cvt_pk_f16_f32 v82, v82, v83
    ds_write_addtid_b32 v40 offset:1040
    ds_write_addtid_b32 v42 offset:1824
    ds_write_addtid_b32 v44 offset:2608
    ds_write_addtid_b32 v46 offset:3392
    ds_write_addtid_b32 v48 offset:4176
    ds_write_addtid_b32 v50 offset:4960
    ds_write_addtid_b32 v52 offset:5744
    ds_write_addtid_b32 v54 offset:6528
    ds_write_addtid_b32 v56 offset:7312
    ds_write_addtid_b32 v58 offset:8096
    ds_write_addtid_b32 v60 offset:8880
    ds_write_addtid_b32 v62 offset:9664
    ds_write_addtid_b32 v64 offset:10448
    ds_write_addtid_b32 v66 offset:11232
    ds_write_addtid_b32 v68 offset:12016
    ds_write_addtid_b32 v70 offset:12800
    ds_write_addtid_b32 v72 offset:13584
    ds_write_addtid_b32 v74 offset:14368
    ds_write_addtid_b32 v76 offset:15152
    ds_write_addtid_b32 v78 offset:15936
    ds_write_addtid_b32 v80 offset:16720
    ds_write_addtid_b32 v82 offset:17504
    v_exp_f32 v84, v20
    v_fract_f32 v85, v21
    v_cos_f32 v54, v85
    v_sin_f32 v55, v85
    v_mul_f32 v54, v54, v84
    v_mul_f32 v55, v55, v84
    v_mul_f32 v84, 0x42800000, v20
    v_mul_f32 v85, 0x42800000, v21
    v_exp_f32 v84, v84
    v_fract_f32 v85, v85
    v_cos_f32 v48, v85
    v_sin_f32 v49, v85
    v_mul_f32 v48, v48, v84
    v_mul_f32 v49, v49, v84
    v_pk_mul_f32 v[56:57], v[54:55], v[54:55] op_sel_hi:[0,1]
    v_pk_fma_f32 v[56:57], v[54:55], v[54:55], v[56:57] op_sel:[1,1,0] op_sel_hi:[1,0,1] neg_lo:[0,1,0]
    v_pk_mul_f32 v[50:51], v[48:49], v[48:49] op_sel_hi:[0,1]
    v_pk_fma_f32 v[50:51], v[48:49], v[48:49], v[50:51] op_sel:[1,1,0] op_sel_hi:[1,0,1] neg_lo:[0,1,0]
    v_pk_mul_f32 v[58:59], v[56:57], v[54:55] op_sel_hi:[0,1]
    v_pk_fma_f32 v[58:59], v[56:57], v[54:55], v[58:59] op_sel:[1,1,0] op_sel_hi:[1,0,1] neg_lo:[0,1,0]
    v_pk_mul_f32 v[60:61], v[56:57], v[56:57] op_sel_hi:[0,1]
    v_pk_fma_f32 v[60:61], v[56:57], v[56:57], v[60:61] op_sel:[1,1,0] op_sel_hi:[1,0,1] neg_lo:[0,1,0]
    v_pk_mul_f32 v[52:53], v[50:51], v[48:49] op_sel_hi:[0,1]
    v_pk_fma_f32 v[52:53], v[50:51], v[48:49], v[52:53] op_sel:[1,1,0] op_sel_hi:[1,0,1] neg_lo:[0,1,0]
    v_pk_mul_f32 v[68:69], v[50:51], v[50:51] op_sel_hi:[0,1]
    v_pk_fma_f32 v[68:69], v[50:51], v[50:51], v[68:69] op_sel:[1,1,0] op_sel_hi:[1,0,1] neg_lo:[0,1,0]
    v_pk_mul_f32 v[62:63], v[60:61], v[60:61] op_sel_hi:[0,1]
    v_pk_fma_f32 v[62:63], v[60:61], v[60:61], v[62:63] op_sel:[1,1,0] op_sel_hi:[1,0,1] neg_lo:[0,1,0]
    v_pk_mul_f32 v[70:71], v[68:69], v[68:69] op_sel_hi:[0,1]
    v_pk_fma_f32 v[70:71], v[68:69], v[68:69], v[70:71] op_sel:[1,1,0] op_sel_hi:[1,0,1] neg_lo:[0,1,0]
    v_pk_mul_f32 v[64:65], v[62:63], v[60:61] op_sel_hi:[0,1]
    v_pk_fma_f32 v[64:65], v[62:63], v[60:61], v[64:65] op_sel:[1,1,0] op_sel_hi:[1,0,1] neg_lo:[0,1,0]
    v_pk_mul_f32 v[66:67], v[62:63], v[62:63] op_sel_hi:[0,1]
    v_pk_fma_f32 v[66:67], v[62:63], v[62:63], v[66:67] op_sel:[1,1,0] op_sel_hi:[1,0,1] neg_lo:[0,1,0]
    v_pk_mul_f32 v[72:73], v[70:71], v[68:69] op_sel_hi:[0,1]
    v_pk_fma_f32 v[72:73], v[70:71], v[68:69], v[72:73] op_sel:[1,1,0] op_sel_hi:[1,0,1] neg_lo:[0,1,0]
    v_pk_mul_f32 v[74:75], v[70:71], v[70:71] op_sel_hi:[0,1]
    v_pk_fma_f32 v[74:75], v[70:71], v[70:71], v[74:75] op_sel:[1,1,0] op_sel_hi:[1,0,1] neg_lo:[0,1,0]
    v_pk_mul_f32 v[42:43], v[22:23], v[66:67] op_sel_hi:[0,1]
    v_pk_fma_f32 v[42:43], v[22:23], v[66:67], v[42:43] op_sel:[1,1,0] op_sel_hi:[1,0,1] neg_lo:[0,1,0]
    v_pk_mul_f32 v[82:83], v[68:69], v[56:57] op_sel_hi:[0,1]
    v_pk_fma_f32 v[82:83], v[68:69], v[56:57], v[82:83] op_sel:[1,1,0] op_sel_hi:[1,0,1] neg_lo:[0,1,0]
    v_pk_mul_f32 v[76:77], v[74:75], v[68:69] op_sel_hi:[0,1]
    v_pk_fma_f32 v[76:77], v[74:75], v[68:69], v[76:77] op_sel:[1,1,0] op_sel_hi:[1,0,1] neg_lo:[0,1,0]
    v_pk_mul_f32 v[44:45], v[42:43], v[66:67] op_sel_hi:[0,1]
    v_pk_fma_f32 v[44:45], v[42:43], v[66:67], v[44:45] op_sel:[1,1,0] op_sel_hi:[1,0,1] neg_lo:[0,1,0]
    v_pk_mul_f32 v[78:79], v[74:75], v[70:71] op_sel_hi:[0,1]
    v_pk_fma_f32 v[78:79], v[74:75], v[70:71], v[78:79] op_sel:[1,1,0] op_sel_hi:[1,0,1] neg_lo:[0,1,0]
    v_pk_mul_f32 v[80:81], v[74:75], v[72:73] op_sel_hi:[0,1]
    v_pk_fma_f32 v[80:81], v[74:75], v[72:73], v[80:81] op_sel:[1,1,0] op_sel_hi:[1,0,1] neg_lo:[0,1,0]
    v_pk_mul_f32 v[46:47], v[44:45], v[66:67] op_sel_hi:[0,1]
    v_pk_fma_f32 v[46:47], v[44:45], v[66:67], v[46:47] op_sel:[1,1,0] op_sel_hi:[1,0,1] neg_lo:[0,1,0]
    v_cvt_pk_f16_f32 v40, v22, v23
    v_cvt_pk_f16_f32 v42, v42, v43
    v_cvt_pk_f16_f32 v44, v44, v45
    v_cvt_pk_f16_f32 v46, v46, v47
    v_cvt_pk_f16_f32 v48, v48, v49
    v_cvt_pk_f16_f32 v50, v50, v51
    v_cvt_pk_f16_f32 v52, v52, v53
    v_cvt_pk_f16_f32 v54, v54, v55
    v_cvt_pk_f16_f32 v56, v56, v57
    v_cvt_pk_f16_f32 v58, v58, v59
    v_cvt_pk_f16_f32 v60, v60, v61
    v_cvt_pk_f16_f32 v62, v62, v63
    v_cvt_pk_f16_f32 v64, v64, v65
    v_cvt_pk_f16_f32 v66, v66, v67
    v_cvt_pk_f16_f32 v68, v68, v69
    v_cvt_pk_f16_f32 v70, v70, v71
    v_cvt_pk_f16_f32 v72, v72, v73
    v_cvt_pk_f16_f32 v74, v74, v75
    v_cvt_pk_f16_f32 v76, v76, v77
    v_cvt_pk_f16_f32 v78, v78, v79
    v_cvt_pk_f16_f32 v80, v80, v81
    v_cvt_pk_f16_f32 v82, v82, v83
    ds_write_addtid_b32 v40 offset:1296
    ds_write_addtid_b32 v42 offset:2080
    ds_write_addtid_b32 v44 offset:2864
    ds_write_addtid_b32 v46 offset:3648
    ds_write_addtid_b32 v48 offset:4432
    ds_write_addtid_b32 v50 offset:5216
    ds_write_addtid_b32 v52 offset:6000
    ds_write_addtid_b32 v54 offset:6784
    ds_write_addtid_b32 v56 offset:7568
    ds_write_addtid_b32 v58 offset:8352
    ds_write_addtid_b32 v60 offset:9136
    ds_write_addtid_b32 v62 offset:9920
    ds_write_addtid_b32 v64 offset:10704
    ds_write_addtid_b32 v66 offset:11488
    ds_write_addtid_b32 v68 offset:12272
    ds_write_addtid_b32 v70 offset:13056
    ds_write_addtid_b32 v72 offset:13840
    ds_write_addtid_b32 v74 offset:14624
    ds_write_addtid_b32 v76 offset:15408
    ds_write_addtid_b32 v78 offset:16192
    ds_write_addtid_b32 v80 offset:16976
    ds_write_addtid_b32 v82 offset:17760
    ds_read_b128 v[104:107], v2 offset:0
    ds_read_b128 v[108:111], v2 offset:16
    ds_read_b128 v[112:115], v2 offset:32
    ds_read_b128 v[116:119], v2 offset:48
    ds_read_b128 v[120:123], v3 offset:0
    ds_read_b128 v[124:127], v3 offset:16
    ds_read_b128 v[128:131], v3 offset:32
    ds_read_b128 v[132:135], v3 offset:48
    ds_read_b128 v[136:139], v12 offset:0
    ds_read_b128 v[140:143], v12 offset:16
    ds_read_b128 v[144:147], v12 offset:32
    ds_read_b128 v[148:151], v12 offset:48
    ds_read_b128 v[168:171], v18 offset:0
    ds_read_b128 v[172:175], v18 offset:16
    ds_read_b128 v[176:179], v18 offset:32
    ds_read_b128 v[180:183], v18 offset:48
    ds_read_b128 v[152:155], v13 offset:0
    ds_read_b128 v[156:159], v13 offset:16
    ds_read_b128 v[160:163], v13 offset:32
    ds_read_b128 v[164:167], v13 offset:48
    ds_read_b128 v[184:187], v19 offset:0
    ds_read_b128 v[188:191], v19 offset:16
    ds_read_b128 v[192:195], v19 offset:32
    ds_read_b128 v[196:199], v19 offset:48
    ds_read_b128 v[200:203], v24 offset:0
    ds_read_b128 v[204:207], v24 offset:16
    ds_read_b128 v[208:211], v24 offset:32
    ds_read_b128 v[212:215], v24 offset:48
    v_mov_b32 v25, 0
    ds_read_b32 v25, v25 offset:80
    s_setprio 0
    s_waitcnt lgkmcnt(0)
    v_readfirstlane_b32 s70, v25
    s_nop 0
    s_cmp_eq_u32 s70, 0
    s_cbranch_scc1 .dy_57
    s_setprio 1
.dy_57:
    v_pk_mul_f16 v40, v104, v120 op_sel_hi:[0,1]
    v_pk_mul_f16 v41, v105, v121 op_sel_hi:[0,1]
    v_pk_fma_f16 v40, v104, v120, v40 op_sel:[1,1,0] op_sel_hi:[1,0,1] neg_lo:[0,1,0] neg_hi:[1,0,1]
    v_pk_fma_f16 v41, v105, v121, v41 op_sel:[1,1,0] op_sel_hi:[1,0,1] neg_lo:[0,1,0] neg_hi:[1,0,1]
    v_pk_mul_f16 v42, v106, v122 op_sel_hi:[0,1]
    v_pk_mul_f16 v43, v107, v123 op_sel_hi:[0,1]
    v_pk_fma_f16 v42, v106, v122, v42 op_sel:[1,1,0] op_sel_hi:[1,0,1] neg_lo:[0,1,0] neg_hi:[1,0,1]
    v_pk_fma_f16 v43, v107, v123, v43 op_sel:[1,1,0] op_sel_hi:[1,0,1] neg_lo:[0,1,0] neg_hi:[1,0,1]
    ds_read_b128 v[104:107], v2 offset:256
    v_pk_mul_f16 v44, v108, v124 op_sel_hi:[0,1]
    v_pk_mul_f16 v45, v109, v125 op_sel_hi:[0,1]
    v_pk_fma_f16 v44, v108, v124, v44 op_sel:[1,1,0] op_sel_hi:[1,0,1] neg_lo:[0,1,0] neg_hi:[1,0,1]
    v_pk_fma_f16 v45, v109, v125, v45 op_sel:[1,1,0] op_sel_hi:[1,0,1] neg_lo:[0,1,0] neg_hi:[1,0,1]
    ds_read_b128 v[120:123], v3 offset:256
    v_pk_mul_f16 v46, v110, v126 op_sel_hi:[0,1]
    v_pk_mul_f16 v47, v111, v127 op_sel_hi:[0,1]
    v_pk_fma_f16 v46, v110, v126, v46 op_sel:[1,1,0] op_sel_hi:[1,0,1] neg_lo:[0,1,0] neg_hi:[1,0,1]
    v_pk_fma_f16 v47, v111, v127, v47 op_sel:[1,1,0] op_sel_hi:[1,0,1] neg_lo:[0,1,0] neg_hi:[1,0,1]
    ds_read_b128 v[108:111], v2 offset:272
    v_pk_mul_f16 v48, v112, v128 op_sel_hi:[0,1]
    v_pk_mul_f16 v49, v113, v129 op_sel_hi:[0,1]
    v_pk_fma_f16 v48, v112, v128, v48 op_sel:[1,1,0] op_sel_hi:[1,0,1] neg_lo:[0,1,0] neg_hi:[1,0,1]
    v_pk_fma_f16 v49, v113, v129, v49 op_sel:[1,1,0] op_sel_hi:[1,0,1] neg_lo:[0,1,0] neg_hi:[1,0,1]
    ds_read_b128 v[124:127], v3 offset:272
    v_pk_mul_f16 v50, v114, v130 op_sel_hi:[0,1]
    v_pk_mul_f16 v51, v115, v131 op_sel_hi:[0,1]
    v_pk_fma_f16 v50, v114, v130, v50 op_sel:[1,1,0] op_sel_hi:[1,0,1] neg_lo:[0,1,0] neg_hi:[1,0,1]
    v_pk_fma_f16 v51, v115, v131, v51 op_sel:[1,1,0] op_sel_hi:[1,0,1] neg_lo:[0,1,0] neg_hi:[1,0,1]
    ds_read_b128 v[112:115], v2 offset:288
    v_pk_mul_f16 v52, v116, v132 op_sel_hi:[0,1]
    v_pk_mul_f16 v53, v117, v133 op_sel_hi:[0,1]
    v_pk_fma_f16 v52, v116, v132, v52 op_sel:[1,1,0] op_sel_hi:[1,0,1] neg_lo:[0,1,0] neg_hi:[1,0,1]
    v_pk_fma_f16 v53, v117, v133, v53 op_sel:[1,1,0] op_sel_hi:[1,0,1] neg_lo:[0,1,0] neg_hi:[1,0,1]
    ds_read_b128 v[128:131], v3 offset:288
    v_pk_mul_f16 v54, v118, v134 op_sel_hi:[0,1]
    v_pk_mul_f16 v55, v119, v135 op_sel_hi:[0,1]
    v_pk_fma_f16 v54, v118, v134, v54 op_sel:[1,1,0] op_sel_hi:[1,0,1] neg_lo:[0,1,0] neg_hi:[1,0,1]
    v_pk_fma_f16 v55, v119, v135, v55 op_sel:[1,1,0] op_sel_hi:[1,0,1] neg_lo:[0,1,0] neg_hi:[1,0,1]
    ds_read_b128 v[116:119], v2 offset:304
    v_pk_mul_f16 v56, v136, v168 op_sel_hi:[0,1]
    v_pk_mul_f16 v57, v137, v169 op_sel_hi:[0,1]
    v_pk_fma_f16 v56, v136, v168, v56 op_sel:[1,1,0] op_sel_hi:[1,0,1] neg_lo:[0,1,0]
    v_pk_fma_f16 v57, v137, v169, v57 op_sel:[1,1,0] op_sel_hi:[1,0,1] neg_lo:[0,1,0]
    ds_read_b128 v[132:135], v3 offset:304
    v_pk_mul_f16 v58, v138, v170 op_sel_hi:[0,1]
    v_pk_mul_f16 v59, v139, v171 op_sel_hi:[0,1]
    v_pk_fma_f16 v58, v138, v170, v58 op_sel:[1,1,0] op_sel_hi:[1,0,1] neg_lo:[0,1,0]
    v_pk_fma_f16 v59, v139, v171, v59 op_sel:[1,1,0] op_sel_hi:[1,0,1] neg_lo:[0,1,0]
    ds_read_b128 v[136:139], v12 offset:256
    v_pk_mul_f16 v60, v140, v172 op_sel_hi:[0,1]
    v_pk_mul_f16 v61, v141, v173 op_sel_hi:[0,1]
    v_pk_fma_f16 v60, v140, v172, v60 op_sel:[1,1,0] op_sel_hi:[1,0,1] neg_lo:[0,1,0]
    v_pk_fma_f16 v61, v141, v173, v61 op_sel:[1,1,0] op_sel_hi:[1,0,1] neg_lo:[0,1,0]
    v_pk_mul_f16 v62, v142, v174 op_sel_hi:[0,1]
    v_pk_mul_f16 v63, v143, v175 op_sel_hi:[0,1]
    v_pk_fma_f16 v62, v142, v174, v62 op_sel:[1,1,0] op_sel_hi:[1,0,1] neg_lo:[0,1,0]
    v_pk_fma_f16 v63, v143, v175, v63 op_sel:[1,1,0] op_sel_hi:[1,0,1] neg_lo:[0,1,0]
    ds_read_b128 v[140:143], v12 offset:272
    v_pk_mul_f16 v64, v144, v176 op_sel_hi:[0,1]
    v_pk_mul_f16 v65, v145, v177 op_sel_hi:[0,1]
    v_pk_fma_f16 v64, v144, v176, v64 op_sel:[1,1,0] op_sel_hi:[1,0,1] neg_lo:[0,1,0]
    v_pk_fma_f16 v65, v145, v177, v65 op_sel:[1,1,0] op_sel_hi:[1,0,1] neg_lo:[0,1,0]
    v_pk_mul_f16 v66, v146, v178 op_sel_hi:[0,1]
    v_pk_mul_f16 v67, v147, v179 op_sel_hi:[0,1]
    v_pk_fma_f16 v66, v146, v178, v66 op_sel:[1,1,0] op_sel_hi:[1,0,1] neg_lo:[0,1,0]
    v_pk_fma_f16 v67, v147, v179, v67 op_sel:[1,1,0] op_sel_hi:[1,0,1] neg_lo:[0,1,0]
    ds_read_b128 v[144:147], v12 offset:288
    v_pk_mul_f16 v68, v148, v180 op_sel_hi:[0,1]
    v_pk_mul_f16 v69, v149, v181 op_sel_hi:[0,1]
    v_pk_fma_f16 v68, v148, v180, v68 op_sel:[1,1,0] op_sel_hi:[1,0,1] neg_lo:[0,1,0]
    v_pk_fma_f16 v69, v149, v181, v69 op_sel:[1,1,0] op_sel_hi:[1,0,1] neg_lo:[0,1,0]
    v_pk_mul_f16 v70, v150, v182 op_sel_hi:[0,1]
    v_pk_mul_f16 v71, v151, v183 op_sel_hi:[0,1]
    v_pk_fma_f16 v70, v150, v182, v70 op_sel:[1,1,0] op_sel_hi:[1,0,1] neg_lo:[0,1,0]
    v_pk_fma_f16 v71, v151, v183, v71 op_sel:[1,1,0] op_sel_hi:[1,0,1] neg_lo:[0,1,0]
    ds_read_b128 v[148:151], v12 offset:304
    v_pk_mul_f16 v72, v152, v168 op_sel_hi:[0,1]
    v_pk_mul_f16 v73, v153, v169 op_sel_hi:[0,1]
    v_pk_fma_f16 v72, v152, v168, v72 op_sel:[1,1,0] op_sel_hi:[1,0,1] neg_lo:[0,1,0]
    v_pk_fma_f16 v73, v153, v169, v73 op_sel:[1,1,0] op_sel_hi:[1,0,1] neg_lo:[0,1,0]
    v_pk_mul_f16 v74, v154, v170 op_sel_hi:[0,1]
    v_pk_mul_f16 v75, v155, v171 op_sel_hi:[0,1]
    v_pk_fma_f16 v74, v154, v170, v74 op_sel:[1,1,0] op_sel_hi:[1,0,1] neg_lo:[0,1,0]
    v_pk_fma_f16 v75, v155, v171, v75 op_sel:[1,1,0] op_sel_hi:[1,0,1] neg_lo:[0,1,0]
    ds_read_b128 v[168:171], v18 offset:256
    v_pk_mul_f16 v76, v156, v172 op_sel_hi:[0,1]
    v_pk_mul_f16 v77, v157, v173 op_sel_hi:[0,1]
    v_pk_fma_f16 v76, v156, v172, v76 op_sel:[1,1,0] op_sel_hi:[1,0,1] neg_lo:[0,1,0]
    v_pk_fma_f16 v77, v157, v173, v77 op_sel:[1,1,0] op_sel_hi:[1,0,1] neg_lo:[0,1,0]
    ds_read_b128 v[152:155], v13 offset:256
    v_pk_mul_f16 v78, v158, v174 op_sel_hi:[0,1]
    v_pk_mul_f16 v79, v159, v175 op_sel_hi:[0,1]
    v_pk_fma_f16 v78, v158, v174, v78 op_sel:[1,1,0] op_sel_hi:[1,0,1] neg_lo:[0,1,0]
    v_pk_fma_f16 v79, v159, v175, v79 op_sel:[1,1,0] op_sel_hi:[1,0,1] neg_lo:[0,1,0]
    ds_read_b128 v[172:175], v18 offset:272
    v_pk_mul_f16 v80, v160, v176 op_sel_hi:[0,1]
    v_pk_mul_f16 v81, v161, v177 op_sel_hi:[0,1]
    v_pk_fma_f16 v80, v160, v176, v80 op_sel:[1,1,0] op_sel_hi:[1,0,1] neg_lo:[0,1,0]
    v_pk_fma_f16 v81, v161, v177, v81 op_sel:[1,1,0] op_sel_hi:[1,0,1] neg_lo:[0,1,0]
    ds_read_b128 v[156:159], v13 offset:272
    v_pk_mul_f16 v82, v162, v178 op_sel_hi:[0,1]
    v_pk_mul_f16 v83, v163, v179 op_sel_hi:[0,1]
    v_pk_fma_f16 v82, v162, v178, v82 op_sel:[1,1,0] op_sel_hi:[1,0,1] neg_lo:[0,1,0]
    v_pk_fma_f16 v83, v163, v179, v83 op_sel:[1,1,0] op_sel_hi:[1,0,1] neg_lo:[0,1,0]
    ds_read_b128 v[176:179], v18 offset:288
    v_pk_mul_f16 v84, v164, v180 op_sel_hi:[0,1]
    v_pk_mul_f16 v85, v165, v181 op_sel_hi:[0,1]
    v_pk_fma_f16 v84, v164, v180, v84 op_sel:[1,1,0] op_sel_hi:[1,0,1] neg_lo:[0,1,0]
    v_pk_fma_f16 v85, v165, v181, v85 op_sel:[1,1,0] op_sel_hi:[1,0,1] neg_lo:[0,1,0]
    ds_read_b128 v[160:163], v13 offset:288
    v_pk_mul_f16 v86, v166, v182 op_sel_hi:[0,1]
    v_pk_mul_f16 v87, v167, v183 op_sel_hi:[0,1]
    v_pk_fma_f16 v86, v166, v182, v86 op_sel:[1,1,0] op_sel_hi:[1,0,1] neg_lo:[0,1,0]
    v_pk_fma_f16 v87, v167, v183, v87 op_sel:[1,1,0] op_sel_hi:[1,0,1] neg_lo:[0,1,0]
    ds_read_b128 v[180:183], v18 offset:304
    v_pk_mul_f16 v88, v184, v200 op_sel_hi:[0,1]
    v_pk_mul_f16 v89, v185, v201 op_sel_hi:[0,1]
    v_pk_fma_f16 v88, v184, v200, v88 op_sel:[1,1,0] op_sel_hi:[1,0,1] neg_lo:[0,1,0]
    v_pk_fma_f16 v89, v185, v201, v89 op_sel:[1,1,0] op_sel_hi:[1,0,1] neg_lo:[0,1,0]
    ds_read_b128 v[164:167], v13 offset:304
    v_pk_mul_f16 v90, v186, v202 op_sel_hi:[0,1]
    v_pk_mul_f16 v91, v187, v203 op_sel_hi:[0,1]
    v_pk_fma_f16 v90, v186, v202, v90 op_sel:[1,1,0] op_sel_hi:[1,0,1] neg_lo:[0,1,0]
    v_pk_fma_f16 v91, v187, v203, v91 op_sel:[1,1,0] op_sel_hi:[1,0,1] neg_lo:[0,1,0]
    ds_read_b128 v[184:187], v19 offset:256
    v_pk_mul_f16 v92, v188, v204 op_sel_hi:[0,1]
    v_pk_mul_f16 v93, v189, v205 op_sel_hi:[0,1]
    v_pk_fma_f16 v92, v188, v204, v92 op_sel:[1,1,0] op_sel_hi:[1,0,1] neg_lo:[0,1,0]
    v_pk_fma_f16 v93, v189, v205, v93 op_sel:[1,1,0] op_sel_hi:[1,0,1] neg_lo:[0,1,0]
    ds_read_b128 v[200:203], v24 offset:256
    v_pk_mul_f16 v94, v190, v206 op_sel_hi:[0,1]
    v_pk_mul_f16 v95, v191, v207 op_sel_hi:[0,1]
    v_pk_fma_f16 v94, v190, v206, v94 op_sel:[1,1,0] op_sel_hi:[1,0,1] neg_lo:[0,1,0]
    v_pk_fma_f16 v95, v191, v207, v95 op_sel:[1,1,0] op_sel_hi:[1,0,1] neg_lo:[0,1,0]
    ds_read_b128 v[188:191], v19 offset:272
    v_pk_mul_f16 v96, v192, v208 op_sel_hi:[0,1]
    v_pk_mul_f16 v97, v193, v209 op_sel_hi:[0,1]
    v_pk_fma_f16 v96, v192, v208, v96 op_sel:[1,1,0] op_sel_hi:[1,0,1] neg_lo:[0,1,0]
    v_pk_fma_f16 v97, v193, v209, v97 op_sel:[1,1,0] op_sel_hi:[1,0,1] neg_lo:[0,1,0]
    ds_read_b128 v[204:207], v24 offset:272
    v_pk_mul_f16 v98, v194, v210 op_sel_hi:[0,1]
    v_pk_mul_f16 v99, v195, v211 op_sel_hi:[0,1]
    v_pk_fma_f16 v98, v194, v210, v98 op_sel:[1,1,0] op_sel_hi:[1,0,1] neg_lo:[0,1,0]
    v_pk_fma_f16 v99, v195, v211, v99 op_sel:[1,1,0] op_sel_hi:[1,0,1] neg_lo:[0,1,0]
    ds_read_b128 v[192:195], v19 offset:288
    v_pk_mul_f16 v100, v196, v212 op_sel_hi:[0,1]
    v_pk_mul_f16 v101, v197, v213 op_sel_hi:[0,1]
    v_pk_fma_f16 v100, v196, v212, v100 op_sel:[1,1,0] op_sel_hi:[1,0,1] neg_lo:[0,1,0]
    v_pk_fma_f16 v101, v197, v213, v101 op_sel:[1,1,0] op_sel_hi:[1,0,1] neg_lo:[0,1,0]
    ds_read_b128 v[208:211], v24 offset:288
    v_pk_mul_f16 v102, v198, v214 op_sel_hi:[0,1]
    v_pk_mul_f16 v103, v199, v215 op_sel_hi:[0,1]
    v_pk_fma_f16 v102, v198, v214, v102 op_sel:[1,1,0] op_sel_hi:[1,0,1] neg_lo:[0,1,0]
    v_pk_fma_f16 v103, v199, v215, v103 op_sel:[1,1,0] op_sel_hi:[1,0,1] neg_lo:[0,1,0]
    ds_read_b128 v[196:199], v19 offset:304
    ds_read_b128 v[212:215], v24 offset:304
    v_mov_b32_e64 v25, 0
    ds_read_b32 v25, v25 offset:88
    v_mfma_f32_16x16x32_f16 v[28:31], v[40:43], v[56:59], v[28:31]
    v_mfma_f32_16x16x32_f16 v[32:35], v[40:43], v[72:75], v[32:35]
    v_mfma_f32_16x16x32_f16 v[36:39], v[40:43], v[88:91], v[36:39]
    v_mfma_f32_16x16x32_f16 v[28:31], v[44:47], v[60:63], v[28:31]
    v_mfma_f32_16x16x32_f16 v[32:35], v[44:47], v[76:79], v[32:35]
    v_mfma_f32_16x16x32_f16 v[36:39], v[44:47], v[92:95], v[36:39]
    v_mfma_f32_16x16x32_f16 v[28:31], v[48:51], v[64:67], v[28:31]
    v_mfma_f32_16x16x32_f16 v[32:35], v[48:51], v[80:83], v[32:35]
    v_mfma_f32_16x16x32_f16 v[36:39], v[48:51], v[96:99], v[36:39]
    v_mfma_f32_16x16x32_f16 v[28:31], v[52:55], v[68:71], v[28:31]
    v_mfma_f32_16x16x32_f16 v[32:35], v[52:55], v[84:87], v[32:35]
    v_mfma_f32_16x16x32_f16 v[36:39], v[52:55], v[100:103], v[36:39]
    s_waitcnt lgkmcnt(0)
    v_readfirstlane_b32 s70, v25
    s_nop 0
    s_cmp_eq_u32 s70, 0
    s_cbranch_scc1 .dy_58
    s_setprio 1
.dy_58:
    v_pk_mul_f16 v40, v104, v120 op_sel_hi:[0,1]
    v_pk_mul_f16 v41, v105, v121 op_sel_hi:[0,1]
    v_pk_fma_f16 v40, v104, v120, v40 op_sel:[1,1,0] op_sel_hi:[1,0,1] neg_lo:[0,1,0] neg_hi:[1,0,1]
    v_pk_fma_f16 v41, v105, v121, v41 op_sel:[1,1,0] op_sel_hi:[1,0,1] neg_lo:[0,1,0] neg_hi:[1,0,1]
    v_pk_mul_f16 v42, v106, v122 op_sel_hi:[0,1]
    v_pk_mul_f16 v43, v107, v123 op_sel_hi:[0,1]
    v_pk_fma_f16 v42, v106, v122, v42 op_sel:[1,1,0] op_sel_hi:[1,0,1] neg_lo:[0,1,0] neg_hi:[1,0,1]
    v_pk_fma_f16 v43, v107, v123, v43 op_sel:[1,1,0] op_sel_hi:[1,0,1] neg_lo:[0,1,0] neg_hi:[1,0,1]
    ds_read_b128 v[104:107], v2 offset:512
    v_pk_mul_f16 v44, v108, v124 op_sel_hi:[0,1]
    v_pk_mul_f16 v45, v109, v125 op_sel_hi:[0,1]
    v_pk_fma_f16 v44, v108, v124, v44 op_sel:[1,1,0] op_sel_hi:[1,0,1] neg_lo:[0,1,0] neg_hi:[1,0,1]
    v_pk_fma_f16 v45, v109, v125, v45 op_sel:[1,1,0] op_sel_hi:[1,0,1] neg_lo:[0,1,0] neg_hi:[1,0,1]
    ds_read_b128 v[120:123], v3 offset:512
    v_pk_mul_f16 v46, v110, v126 op_sel_hi:[0,1]
    v_pk_mul_f16 v47, v111, v127 op_sel_hi:[0,1]
    v_pk_fma_f16 v46, v110, v126, v46 op_sel:[1,1,0] op_sel_hi:[1,0,1] neg_lo:[0,1,0] neg_hi:[1,0,1]
    v_pk_fma_f16 v47, v111, v127, v47 op_sel:[1,1,0] op_sel_hi:[1,0,1] neg_lo:[0,1,0] neg_hi:[1,0,1]
    ds_read_b128 v[108:111], v2 offset:528
    v_pk_mul_f16 v48, v112, v128 op_sel_hi:[0,1]
    v_pk_mul_f16 v49, v113, v129 op_sel_hi:[0,1]
    v_pk_fma_f16 v48, v112, v128, v48 op_sel:[1,1,0] op_sel_hi:[1,0,1] neg_lo:[0,1,0] neg_hi:[1,0,1]
    v_pk_fma_f16 v49, v113, v129, v49 op_sel:[1,1,0] op_sel_hi:[1,0,1] neg_lo:[0,1,0] neg_hi:[1,0,1]
    ds_read_b128 v[124:127], v3 offset:528
    v_pk_mul_f16 v50, v114, v130 op_sel_hi:[0,1]
    v_pk_mul_f16 v51, v115, v131 op_sel_hi:[0,1]
    v_pk_fma_f16 v50, v114, v130, v50 op_sel:[1,1,0] op_sel_hi:[1,0,1] neg_lo:[0,1,0] neg_hi:[1,0,1]
    v_pk_fma_f16 v51, v115, v131, v51 op_sel:[1,1,0] op_sel_hi:[1,0,1] neg_lo:[0,1,0] neg_hi:[1,0,1]
    ds_read_b128 v[112:115], v2 offset:544
    v_pk_mul_f16 v52, v116, v132 op_sel_hi:[0,1]
    v_pk_mul_f16 v53, v117, v133 op_sel_hi:[0,1]
    v_pk_fma_f16 v52, v116, v132, v52 op_sel:[1,1,0] op_sel_hi:[1,0,1] neg_lo:[0,1,0] neg_hi:[1,0,1]
    v_pk_fma_f16 v53, v117, v133, v53 op_sel:[1,1,0] op_sel_hi:[1,0,1] neg_lo:[0,1,0] neg_hi:[1,0,1]
    ds_read_b128 v[128:131], v3 offset:544
    v_pk_mul_f16 v54, v118, v134 op_sel_hi:[0,1]
    v_pk_mul_f16 v55, v119, v135 op_sel_hi:[0,1]
    v_pk_fma_f16 v54, v118, v134, v54 op_sel:[1,1,0] op_sel_hi:[1,0,1] neg_lo:[0,1,0] neg_hi:[1,0,1]
    v_pk_fma_f16 v55, v119, v135, v55 op_sel:[1,1,0] op_sel_hi:[1,0,1] neg_lo:[0,1,0] neg_hi:[1,0,1]
    ds_read_b128 v[116:119], v2 offset:560
    v_pk_mul_f16 v56, v136, v168 op_sel_hi:[0,1]
    v_pk_mul_f16 v57, v137, v169 op_sel_hi:[0,1]
    v_pk_fma_f16 v56, v136, v168, v56 op_sel:[1,1,0] op_sel_hi:[1,0,1] neg_lo:[0,1,0]
    v_pk_fma_f16 v57, v137, v169, v57 op_sel:[1,1,0] op_sel_hi:[1,0,1] neg_lo:[0,1,0]
    ds_read_b128 v[132:135], v3 offset:560
    v_pk_mul_f16 v58, v138, v170 op_sel_hi:[0,1]
    v_pk_mul_f16 v59, v139, v171 op_sel_hi:[0,1]
    v_pk_fma_f16 v58, v138, v170, v58 op_sel:[1,1,0] op_sel_hi:[1,0,1] neg_lo:[0,1,0]
    v_pk_fma_f16 v59, v139, v171, v59 op_sel:[1,1,0] op_sel_hi:[1,0,1] neg_lo:[0,1,0]
    ds_read_b128 v[136:139], v12 offset:512
    v_pk_mul_f16 v60, v140, v172 op_sel_hi:[0,1]
    v_pk_mul_f16 v61, v141, v173 op_sel_hi:[0,1]
    v_pk_fma_f16 v60, v140, v172, v60 op_sel:[1,1,0] op_sel_hi:[1,0,1] neg_lo:[0,1,0]
    v_pk_fma_f16 v61, v141, v173, v61 op_sel:[1,1,0] op_sel_hi:[1,0,1] neg_lo:[0,1,0]
    v_pk_mul_f16 v62, v142, v174 op_sel_hi:[0,1]
    v_pk_mul_f16 v63, v143, v175 op_sel_hi:[0,1]
    v_pk_fma_f16 v62, v142, v174, v62 op_sel:[1,1,0] op_sel_hi:[1,0,1] neg_lo:[0,1,0]
    v_pk_fma_f16 v63, v143, v175, v63 op_sel:[1,1,0] op_sel_hi:[1,0,1] neg_lo:[0,1,0]
    ds_read_b128 v[140:143], v12 offset:528
    v_pk_mul_f16 v64, v144, v176 op_sel_hi:[0,1]
    v_pk_mul_f16 v65, v145, v177 op_sel_hi:[0,1]
    v_pk_fma_f16 v64, v144, v176, v64 op_sel:[1,1,0] op_sel_hi:[1,0,1] neg_lo:[0,1,0]
    v_pk_fma_f16 v65, v145, v177, v65 op_sel:[1,1,0] op_sel_hi:[1,0,1] neg_lo:[0,1,0]
    v_pk_mul_f16 v66, v146, v178 op_sel_hi:[0,1]
    v_pk_mul_f16 v67, v147, v179 op_sel_hi:[0,1]
    v_pk_fma_f16 v66, v146, v178, v66 op_sel:[1,1,0] op_sel_hi:[1,0,1] neg_lo:[0,1,0]
    v_pk_fma_f16 v67, v147, v179, v67 op_sel:[1,1,0] op_sel_hi:[1,0,1] neg_lo:[0,1,0]
    ds_read_b128 v[144:147], v12 offset:544
    v_pk_mul_f16 v68, v148, v180 op_sel_hi:[0,1]
    v_pk_mul_f16 v69, v149, v181 op_sel_hi:[0,1]
    v_pk_fma_f16 v68, v148, v180, v68 op_sel:[1,1,0] op_sel_hi:[1,0,1] neg_lo:[0,1,0]
    v_pk_fma_f16 v69, v149, v181, v69 op_sel:[1,1,0] op_sel_hi:[1,0,1] neg_lo:[0,1,0]
    v_pk_mul_f16 v70, v150, v182 op_sel_hi:[0,1]
    v_pk_mul_f16 v71, v151, v183 op_sel_hi:[0,1]
    v_pk_fma_f16 v70, v150, v182, v70 op_sel:[1,1,0] op_sel_hi:[1,0,1] neg_lo:[0,1,0]
    v_pk_fma_f16 v71, v151, v183, v71 op_sel:[1,1,0] op_sel_hi:[1,0,1] neg_lo:[0,1,0]
    ds_read_b128 v[148:151], v12 offset:560
    v_pk_mul_f16 v72, v152, v168 op_sel_hi:[0,1]
    v_pk_mul_f16 v73, v153, v169 op_sel_hi:[0,1]
    v_pk_fma_f16 v72, v152, v168, v72 op_sel:[1,1,0] op_sel_hi:[1,0,1] neg_lo:[0,1,0]
    v_pk_fma_f16 v73, v153, v169, v73 op_sel:[1,1,0] op_sel_hi:[1,0,1] neg_lo:[0,1,0]
    v_pk_mul_f16 v74, v154, v170 op_sel_hi:[0,1]
    v_pk_mul_f16 v75, v155, v171 op_sel_hi:[0,1]
    v_pk_fma_f16 v74, v154, v170, v74 op_sel:[1,1,0] op_sel_hi:[1,0,1] neg_lo:[0,1,0]
    v_pk_fma_f16 v75, v155, v171, v75 op_sel:[1,1,0] op_sel_hi:[1,0,1] neg_lo:[0,1,0]
    ds_read_b128 v[168:171], v18 offset:512
    v_pk_mul_f16 v76, v156, v172 op_sel_hi:[0,1]
    v_pk_mul_f16 v77, v157, v173 op_sel_hi:[0,1]
    v_pk_fma_f16 v76, v156, v172, v76 op_sel:[1,1,0] op_sel_hi:[1,0,1] neg_lo:[0,1,0]
    v_pk_fma_f16 v77, v157, v173, v77 op_sel:[1,1,0] op_sel_hi:[1,0,1] neg_lo:[0,1,0]
    ds_read_b128 v[152:155], v13 offset:512
    v_pk_mul_f16 v78, v158, v174 op_sel_hi:[0,1]
    v_pk_mul_f16 v79, v159, v175 op_sel_hi:[0,1]
    v_pk_fma_f16 v78, v158, v174, v78 op_sel:[1,1,0] op_sel_hi:[1,0,1] neg_lo:[0,1,0]
    v_pk_fma_f16 v79, v159, v175, v79 op_sel:[1,1,0] op_sel_hi:[1,0,1] neg_lo:[0,1,0]
    ds_read_b128 v[172:175], v18 offset:528
    v_pk_mul_f16 v80, v160, v176 op_sel_hi:[0,1]
    v_pk_mul_f16 v81, v161, v177 op_sel_hi:[0,1]
    v_pk_fma_f16 v80, v160, v176, v80 op_sel:[1,1,0] op_sel_hi:[1,0,1] neg_lo:[0,1,0]
    v_pk_fma_f16 v81, v161, v177, v81 op_sel:[1,1,0] op_sel_hi:[1,0,1] neg_lo:[0,1,0]
    ds_read_b128 v[156:159], v13 offset:528
    v_pk_mul_f16 v82, v162, v178 op_sel_hi:[0,1]
    v_pk_mul_f16 v83, v163, v179 op_sel_hi:[0,1]
    v_pk_fma_f16 v82, v162, v178, v82 op_sel:[1,1,0] op_sel_hi:[1,0,1] neg_lo:[0,1,0]
    v_pk_fma_f16 v83, v163, v179, v83 op_sel:[1,1,0] op_sel_hi:[1,0,1] neg_lo:[0,1,0]
    ds_read_b128 v[176:179], v18 offset:544
    v_pk_mul_f16 v84, v164, v180 op_sel_hi:[0,1]
    v_pk_mul_f16 v85, v165, v181 op_sel_hi:[0,1]
    v_pk_fma_f16 v84, v164, v180, v84 op_sel:[1,1,0] op_sel_hi:[1,0,1] neg_lo:[0,1,0]
    v_pk_fma_f16 v85, v165, v181, v85 op_sel:[1,1,0] op_sel_hi:[1,0,1] neg_lo:[0,1,0]
    ds_read_b128 v[160:163], v13 offset:544
    v_pk_mul_f16 v86, v166, v182 op_sel_hi:[0,1]
    v_pk_mul_f16 v87, v167, v183 op_sel_hi:[0,1]
    v_pk_fma_f16 v86, v166, v182, v86 op_sel:[1,1,0] op_sel_hi:[1,0,1] neg_lo:[0,1,0]
    v_pk_fma_f16 v87, v167, v183, v87 op_sel:[1,1,0] op_sel_hi:[1,0,1] neg_lo:[0,1,0]
    ds_read_b128 v[180:183], v18 offset:560
    v_pk_mul_f16 v88, v184, v200 op_sel_hi:[0,1]
    v_pk_mul_f16 v89, v185, v201 op_sel_hi:[0,1]
    v_pk_fma_f16 v88, v184, v200, v88 op_sel:[1,1,0] op_sel_hi:[1,0,1] neg_lo:[0,1,0]
    v_pk_fma_f16 v89, v185, v201, v89 op_sel:[1,1,0] op_sel_hi:[1,0,1] neg_lo:[0,1,0]
    ds_read_b128 v[164:167], v13 offset:560
    v_pk_mul_f16 v90, v186, v202 op_sel_hi:[0,1]
    v_pk_mul_f16 v91, v187, v203 op_sel_hi:[0,1]
    v_pk_fma_f16 v90, v186, v202, v90 op_sel:[1,1,0] op_sel_hi:[1,0,1] neg_lo:[0,1,0]
    v_pk_fma_f16 v91, v187, v203, v91 op_sel:[1,1,0] op_sel_hi:[1,0,1] neg_lo:[0,1,0]
    ds_read_b128 v[184:187], v19 offset:512
    v_pk_mul_f16 v92, v188, v204 op_sel_hi:[0,1]
    v_pk_mul_f16 v93, v189, v205 op_sel_hi:[0,1]
    v_pk_fma_f16 v92, v188, v204, v92 op_sel:[1,1,0] op_sel_hi:[1,0,1] neg_lo:[0,1,0]
    v_pk_fma_f16 v93, v189, v205, v93 op_sel:[1,1,0] op_sel_hi:[1,0,1] neg_lo:[0,1,0]
    ds_read_b128 v[200:203], v24 offset:512
    v_pk_mul_f16 v94, v190, v206 op_sel_hi:[0,1]
    v_pk_mul_f16 v95, v191, v207 op_sel_hi:[0,1]
    v_pk_fma_f16 v94, v190, v206, v94 op_sel:[1,1,0] op_sel_hi:[1,0,1] neg_lo:[0,1,0]
    v_pk_fma_f16 v95, v191, v207, v95 op_sel:[1,1,0] op_sel_hi:[1,0,1] neg_lo:[0,1,0]
    ds_read_b128 v[188:191], v19 offset:528
    v_pk_mul_f16 v96, v192, v208 op_sel_hi:[0,1]
    v_pk_mul_f16 v97, v193, v209 op_sel_hi:[0,1]
    v_pk_fma_f16 v96, v192, v208, v96 op_sel:[1,1,0] op_sel_hi:[1,0,1] neg_lo:[0,1,0]
    v_pk_fma_f16 v97, v193, v209, v97 op_sel:[1,1,0] op_sel_hi:[1,0,1] neg_lo:[0,1,0]
    ds_read_b128 v[204:207], v24 offset:528
    v_pk_mul_f16 v98, v194, v210 op_sel_hi:[0,1]
    v_pk_mul_f16 v99, v195, v211 op_sel_hi:[0,1]
    v_pk_fma_f16 v98, v194, v210, v98 op_sel:[1,1,0] op_sel_hi:[1,0,1] neg_lo:[0,1,0]
    v_pk_fma_f16 v99, v195, v211, v99 op_sel:[1,1,0] op_sel_hi:[1,0,1] neg_lo:[0,1,0]
    ds_read_b128 v[192:195], v19 offset:544
    v_pk_mul_f16 v100, v196, v212 op_sel_hi:[0,1]
    v_pk_mul_f16 v101, v197, v213 op_sel_hi:[0,1]
    v_pk_fma_f16 v100, v196, v212, v100 op_sel:[1,1,0] op_sel_hi:[1,0,1] neg_lo:[0,1,0]
    v_pk_fma_f16 v101, v197, v213, v101 op_sel:[1,1,0] op_sel_hi:[1,0,1] neg_lo:[0,1,0]
    ds_read_b128 v[208:211], v24 offset:544
    v_pk_mul_f16 v102, v198, v214 op_sel_hi:[0,1]
    v_pk_mul_f16 v103, v199, v215 op_sel_hi:[0,1]
    v_pk_fma_f16 v102, v198, v214, v102 op_sel:[1,1,0] op_sel_hi:[1,0,1] neg_lo:[0,1,0]
    v_pk_fma_f16 v103, v199, v215, v103 op_sel:[1,1,0] op_sel_hi:[1,0,1] neg_lo:[0,1,0]
    ds_read_b128 v[196:199], v19 offset:560
    ds_read_b128 v[212:215], v24 offset:560
    v_mov_b32 v25, 0
    ds_read_b32 v25, v25 offset:96
    s_lshl_b32 s70, s66, 2
    v_mov_b32 v26, 1
    v_mov_b32 v27, s70
    ds_write_b32 v27, v26 offset:476
    v_mfma_f32_16x16x32_f16 v[28:31], v[40:43], v[56:59], v[28:31]
    v_mfma_f32_16x16x32_f16 v[32:35], v[40:43], v[72:75], v[32:35]
    v_mfma_f32_16x16x32_f16 v[36:39], v[40:43], v[88:91], v[36:39]
    v_mfma_f32_16x16x32_f16 v[28:31], v[44:47], v[60:63], v[28:31]
    v_mfma_f32_16x16x32_f16 v[32:35], v[44:47], v[76:79], v[32:35]
    v_mfma_f32_16x16x32_f16 v[36:39], v[44:47], v[92:95], v[36:39]
    v_mfma_f32_16x16x32_f16 v[28:31], v[48:51], v[64:67], v[28:31]
    v_mfma_f32_16x16x32_f16 v[32:35], v[48:51], v[80:83], v[32:35]
    v_mfma_f32_16x16x32_f16 v[36:39], v[48:51], v[96:99], v[36:39]
    v_mfma_f32_16x16x32_f16 v[28:31], v[52:55], v[68:71], v[28:31]
    v_mfma_f32_16x16x32_f16 v[32:35], v[52:55], v[84:87], v[32:35]
    v_mfma_f32_16x16x32_f16 v[36:39], v[52:55], v[100:103], v[36:39]
    s_waitcnt lgkmcnt(1)
    v_readfirstlane_b32 s70, v25
    s_nop 0
    s_cmp_eq_u32 s70, 0
    s_cbranch_scc1 .dy_59
    s_setprio 1
.dy_59:
    v_pk_mul_f16 v40, v104, v120 op_sel_hi:[0,1]
    v_pk_mul_f16 v41, v105, v121 op_sel_hi:[0,1]
    v_pk_fma_f16 v40, v104, v120, v40 op_sel:[1,1,0] op_sel_hi:[1,0,1] neg_lo:[0,1,0] neg_hi:[1,0,1]
    v_pk_fma_f16 v41, v105, v121, v41 op_sel:[1,1,0] op_sel_hi:[1,0,1] neg_lo:[0,1,0] neg_hi:[1,0,1]
    v_pk_mul_f16 v42, v106, v122 op_sel_hi:[0,1]
    v_pk_mul_f16 v43, v107, v123 op_sel_hi:[0,1]
    v_pk_fma_f16 v42, v106, v122, v42 op_sel:[1,1,0] op_sel_hi:[1,0,1] neg_lo:[0,1,0] neg_hi:[1,0,1]
    v_pk_fma_f16 v43, v107, v123, v43 op_sel:[1,1,0] op_sel_hi:[1,0,1] neg_lo:[0,1,0] neg_hi:[1,0,1]
    v_pk_mul_f16 v44, v108, v124 op_sel_hi:[0,1]
    v_pk_mul_f16 v45, v109, v125 op_sel_hi:[0,1]
    v_pk_fma_f16 v44, v108, v124, v44 op_sel:[1,1,0] op_sel_hi:[1,0,1] neg_lo:[0,1,0] neg_hi:[1,0,1]
    v_pk_fma_f16 v45, v109, v125, v45 op_sel:[1,1,0] op_sel_hi:[1,0,1] neg_lo:[0,1,0] neg_hi:[1,0,1]
    v_pk_mul_f16 v46, v110, v126 op_sel_hi:[0,1]
    v_pk_mul_f16 v47, v111, v127 op_sel_hi:[0,1]
    v_pk_fma_f16 v46, v110, v126, v46 op_sel:[1,1,0] op_sel_hi:[1,0,1] neg_lo:[0,1,0] neg_hi:[1,0,1]
    v_pk_fma_f16 v47, v111, v127, v47 op_sel:[1,1,0] op_sel_hi:[1,0,1] neg_lo:[0,1,0] neg_hi:[1,0,1]
    v_pk_mul_f16 v48, v112, v128 op_sel_hi:[0,1]
    v_pk_mul_f16 v49, v113, v129 op_sel_hi:[0,1]
    v_pk_fma_f16 v48, v112, v128, v48 op_sel:[1,1,0] op_sel_hi:[1,0,1] neg_lo:[0,1,0] neg_hi:[1,0,1]
    v_pk_fma_f16 v49, v113, v129, v49 op_sel:[1,1,0] op_sel_hi:[1,0,1] neg_lo:[0,1,0] neg_hi:[1,0,1]
    v_pk_mul_f16 v50, v114, v130 op_sel_hi:[0,1]
    v_pk_mul_f16 v51, v115, v131 op_sel_hi:[0,1]
    v_pk_fma_f16 v50, v114, v130, v50 op_sel:[1,1,0] op_sel_hi:[1,0,1] neg_lo:[0,1,0] neg_hi:[1,0,1]
    v_pk_fma_f16 v51, v115, v131, v51 op_sel:[1,1,0] op_sel_hi:[1,0,1] neg_lo:[0,1,0] neg_hi:[1,0,1]
    v_pk_mul_f16 v52, v116, v132 op_sel_hi:[0,1]
    v_pk_mul_f16 v53, v117, v133 op_sel_hi:[0,1]
    v_pk_fma_f16 v52, v116, v132, v52 op_sel:[1,1,0] op_sel_hi:[1,0,1] neg_lo:[0,1,0] neg_hi:[1,0,1]
    v_pk_fma_f16 v53, v117, v133, v53 op_sel:[1,1,0] op_sel_hi:[1,0,1] neg_lo:[0,1,0] neg_hi:[1,0,1]
    v_pk_mul_f16 v54, v118, v134 op_sel_hi:[0,1]
    v_pk_mul_f16 v55, v119, v135 op_sel_hi:[0,1]
    v_pk_fma_f16 v54, v118, v134, v54 op_sel:[1,1,0] op_sel_hi:[1,0,1] neg_lo:[0,1,0] neg_hi:[1,0,1]
    v_pk_fma_f16 v55, v119, v135, v55 op_sel:[1,1,0] op_sel_hi:[1,0,1] neg_lo:[0,1,0] neg_hi:[1,0,1]
    v_pk_mul_f16 v56, v136, v168 op_sel_hi:[0,1]
    v_pk_mul_f16 v57, v137, v169 op_sel_hi:[0,1]
    v_pk_fma_f16 v56, v136, v168, v56 op_sel:[1,1,0] op_sel_hi:[1,0,1] neg_lo:[0,1,0]
    v_pk_fma_f16 v57, v137, v169, v57 op_sel:[1,1,0] op_sel_hi:[1,0,1] neg_lo:[0,1,0]
    v_pk_mul_f16 v58, v138, v170 op_sel_hi:[0,1]
    v_pk_mul_f16 v59, v139, v171 op_sel_hi:[0,1]
    v_pk_fma_f16 v58, v138, v170, v58 op_sel:[1,1,0] op_sel_hi:[1,0,1] neg_lo:[0,1,0]
    v_pk_fma_f16 v59, v139, v171, v59 op_sel:[1,1,0] op_sel_hi:[1,0,1] neg_lo:[0,1,0]
    v_pk_mul_f16 v60, v140, v172 op_sel_hi:[0,1]
    v_pk_mul_f16 v61, v141, v173 op_sel_hi:[0,1]
    v_pk_fma_f16 v60, v140, v172, v60 op_sel:[1,1,0] op_sel_hi:[1,0,1] neg_lo:[0,1,0]
    v_pk_fma_f16 v61, v141, v173, v61 op_sel:[1,1,0] op_sel_hi:[1,0,1] neg_lo:[0,1,0]
    v_pk_mul_f16 v62, v142, v174 op_sel_hi:[0,1]
    v_pk_mul_f16 v63, v143, v175 op_sel_hi:[0,1]
    v_pk_fma_f16 v62, v142, v174, v62 op_sel:[1,1,0] op_sel_hi:[1,0,1] neg_lo:[0,1,0]
    v_pk_fma_f16 v63, v143, v175, v63 op_sel:[1,1,0] op_sel_hi:[1,0,1] neg_lo:[0,1,0]
    v_pk_mul_f16 v64, v144, v176 op_sel_hi:[0,1]
    v_pk_mul_f16 v65, v145, v177 op_sel_hi:[0,1]
    v_pk_fma_f16 v64, v144, v176, v64 op_sel:[1,1,0] op_sel_hi:[1,0,1] neg_lo:[0,1,0]
    v_pk_fma_f16 v65, v145, v177, v65 op_sel:[1,1,0] op_sel_hi:[1,0,1] neg_lo:[0,1,0]
    v_pk_mul_f16 v66, v146, v178 op_sel_hi:[0,1]
    v_pk_mul_f16 v67, v147, v179 op_sel_hi:[0,1]
    v_pk_fma_f16 v66, v146, v178, v66 op_sel:[1,1,0] op_sel_hi:[1,0,1] neg_lo:[0,1,0]
    v_pk_fma_f16 v67, v147, v179, v67 op_sel:[1,1,0] op_sel_hi:[1,0,1] neg_lo:[0,1,0]
    v_pk_mul_f16 v68, v148, v180 op_sel_hi:[0,1]
    v_pk_mul_f16 v69, v149, v181 op_sel_hi:[0,1]
    v_pk_fma_f16 v68, v148, v180, v68 op_sel:[1,1,0] op_sel_hi:[1,0,1] neg_lo:[0,1,0]
    v_pk_fma_f16 v69, v149, v181, v69 op_sel:[1,1,0] op_sel_hi:[1,0,1] neg_lo:[0,1,0]
    v_pk_mul_f16 v70, v150, v182 op_sel_hi:[0,1]
    v_pk_mul_f16 v71, v151, v183 op_sel_hi:[0,1]
    v_pk_fma_f16 v70, v150, v182, v70 op_sel:[1,1,0] op_sel_hi:[1,0,1] neg_lo:[0,1,0]
    v_pk_fma_f16 v71, v151, v183, v71 op_sel:[1,1,0] op_sel_hi:[1,0,1] neg_lo:[0,1,0]
    v_pk_mul_f16 v72, v152, v168 op_sel_hi:[0,1]
    v_pk_mul_f16 v73, v153, v169 op_sel_hi:[0,1]
    v_pk_fma_f16 v72, v152, v168, v72 op_sel:[1,1,0] op_sel_hi:[1,0,1] neg_lo:[0,1,0]
    v_pk_fma_f16 v73, v153, v169, v73 op_sel:[1,1,0] op_sel_hi:[1,0,1] neg_lo:[0,1,0]
    v_pk_mul_f16 v74, v154, v170 op_sel_hi:[0,1]
    v_pk_mul_f16 v75, v155, v171 op_sel_hi:[0,1]
    v_pk_fma_f16 v74, v154, v170, v74 op_sel:[1,1,0] op_sel_hi:[1,0,1] neg_lo:[0,1,0]
    v_pk_fma_f16 v75, v155, v171, v75 op_sel:[1,1,0] op_sel_hi:[1,0,1] neg_lo:[0,1,0]
    v_pk_mul_f16 v76, v156, v172 op_sel_hi:[0,1]
    v_pk_mul_f16 v77, v157, v173 op_sel_hi:[0,1]
    v_pk_fma_f16 v76, v156, v172, v76 op_sel:[1,1,0] op_sel_hi:[1,0,1] neg_lo:[0,1,0]
    v_pk_fma_f16 v77, v157, v173, v77 op_sel:[1,1,0] op_sel_hi:[1,0,1] neg_lo:[0,1,0]
    v_pk_mul_f16 v78, v158, v174 op_sel_hi:[0,1]
    v_pk_mul_f16 v79, v159, v175 op_sel_hi:[0,1]
    v_pk_fma_f16 v78, v158, v174, v78 op_sel:[1,1,0] op_sel_hi:[1,0,1] neg_lo:[0,1,0]
    v_pk_fma_f16 v79, v159, v175, v79 op_sel:[1,1,0] op_sel_hi:[1,0,1] neg_lo:[0,1,0]
    v_pk_mul_f16 v80, v160, v176 op_sel_hi:[0,1]
    v_pk_mul_f16 v81, v161, v177 op_sel_hi:[0,1]
    v_pk_fma_f16 v80, v160, v176, v80 op_sel:[1,1,0] op_sel_hi:[1,0,1] neg_lo:[0,1,0]
    v_pk_fma_f16 v81, v161, v177, v81 op_sel:[1,1,0] op_sel_hi:[1,0,1] neg_lo:[0,1,0]
    v_pk_mul_f16 v82, v162, v178 op_sel_hi:[0,1]
    v_pk_mul_f16 v83, v163, v179 op_sel_hi:[0,1]
    v_pk_fma_f16 v82, v162, v178, v82 op_sel:[1,1,0] op_sel_hi:[1,0,1] neg_lo:[0,1,0]
    v_pk_fma_f16 v83, v163, v179, v83 op_sel:[1,1,0] op_sel_hi:[1,0,1] neg_lo:[0,1,0]
    v_pk_mul_f16 v84, v164, v180 op_sel_hi:[0,1]
    v_pk_mul_f16 v85, v165, v181 op_sel_hi:[0,1]
    v_pk_fma_f16 v84, v164, v180, v84 op_sel:[1,1,0] op_sel_hi:[1,0,1] neg_lo:[0,1,0]
    v_pk_fma_f16 v85, v165, v181, v85 op_sel:[1,1,0] op_sel_hi:[1,0,1] neg_lo:[0,1,0]
    v_pk_mul_f16 v86, v166, v182 op_sel_hi:[0,1]
    v_pk_mul_f16 v87, v167, v183 op_sel_hi:[0,1]
    v_pk_fma_f16 v86, v166, v182, v86 op_sel:[1,1,0] op_sel_hi:[1,0,1] neg_lo:[0,1,0]
    v_pk_fma_f16 v87, v167, v183, v87 op_sel:[1,1,0] op_sel_hi:[1,0,1] neg_lo:[0,1,0]
    v_pk_mul_f16 v88, v184, v200 op_sel_hi:[0,1]
    v_pk_mul_f16 v89, v185, v201 op_sel_hi:[0,1]
    v_pk_fma_f16 v88, v184, v200, v88 op_sel:[1,1,0] op_sel_hi:[1,0,1] neg_lo:[0,1,0]
    v_pk_fma_f16 v89, v185, v201, v89 op_sel:[1,1,0] op_sel_hi:[1,0,1] neg_lo:[0,1,0]
    v_pk_mul_f16 v90, v186, v202 op_sel_hi:[0,1]
    v_pk_mul_f16 v91, v187, v203 op_sel_hi:[0,1]
    v_pk_fma_f16 v90, v186, v202, v90 op_sel:[1,1,0] op_sel_hi:[1,0,1] neg_lo:[0,1,0]
    v_pk_fma_f16 v91, v187, v203, v91 op_sel:[1,1,0] op_sel_hi:[1,0,1] neg_lo:[0,1,0]
    v_pk_mul_f16 v92, v188, v204 op_sel_hi:[0,1]
    v_pk_mul_f16 v93, v189, v205 op_sel_hi:[0,1]
    v_pk_fma_f16 v92, v188, v204, v92 op_sel:[1,1,0] op_sel_hi:[1,0,1] neg_lo:[0,1,0]
    v_pk_fma_f16 v93, v189, v205, v93 op_sel:[1,1,0] op_sel_hi:[1,0,1] neg_lo:[0,1,0]
    v_pk_mul_f16 v94, v190, v206 op_sel_hi:[0,1]
    v_pk_mul_f16 v95, v191, v207 op_sel_hi:[0,1]
    v_pk_fma_f16 v94, v190, v206, v94 op_sel:[1,1,0] op_sel_hi:[1,0,1] neg_lo:[0,1,0]
    v_pk_fma_f16 v95, v191, v207, v95 op_sel:[1,1,0] op_sel_hi:[1,0,1] neg_lo:[0,1,0]
    v_pk_mul_f16 v96, v192, v208 op_sel_hi:[0,1]
    v_pk_mul_f16 v97, v193, v209 op_sel_hi:[0,1]
    v_pk_fma_f16 v96, v192, v208, v96 op_sel:[1,1,0] op_sel_hi:[1,0,1] neg_lo:[0,1,0]
    v_pk_fma_f16 v97, v193, v209, v97 op_sel:[1,1,0] op_sel_hi:[1,0,1] neg_lo:[0,1,0]
    v_pk_mul_f16 v98, v194, v210 op_sel_hi:[0,1]
    v_pk_mul_f16 v99, v195, v211 op_sel_hi:[0,1]
    v_pk_fma_f16 v98, v194, v210, v98 op_sel:[1,1,0] op_sel_hi:[1,0,1] neg_lo:[0,1,0]
    v_pk_fma_f16 v99, v195, v211, v99 op_sel:[1,1,0] op_sel_hi:[1,0,1] neg_lo:[0,1,0]
    v_pk_mul_f16 v100, v196, v212 op_sel_hi:[0,1]
    v_pk_mul_f16 v101, v197, v213 op_sel_hi:[0,1]
    v_pk_fma_f16 v100, v196, v212, v100 op_sel:[1,1,0] op_sel_hi:[1,0,1] neg_lo:[0,1,0]
    v_pk_fma_f16 v101, v197, v213, v101 op_sel:[1,1,0] op_sel_hi:[1,0,1] neg_lo:[0,1,0]
    v_pk_mul_f16 v102, v198, v214 op_sel_hi:[0,1]
    v_pk_mul_f16 v103, v199, v215 op_sel_hi:[0,1]
    v_pk_fma_f16 v102, v198, v214, v102 op_sel:[1,1,0] op_sel_hi:[1,0,1] neg_lo:[0,1,0]
    v_pk_fma_f16 v103, v199, v215, v103 op_sel:[1,1,0] op_sel_hi:[1,0,1] neg_lo:[0,1,0]
    v_mfma_f32_16x16x32_f16 v[28:31], v[40:43], v[56:59], v[28:31]
    v_mfma_f32_16x16x32_f16 v[32:35], v[40:43], v[72:75], v[32:35]
    v_mfma_f32_16x16x32_f16 v[36:39], v[40:43], v[88:91], v[36:39]
    v_mfma_f32_16x16x32_f16 v[28:31], v[44:47], v[60:63], v[28:31]
    v_mfma_f32_16x16x32_f16 v[32:35], v[44:47], v[76:79], v[32:35]
    v_mfma_f32_16x16x32_f16 v[36:39], v[44:47], v[92:95], v[36:39]
    v_mfma_f32_16x16x32_f16 v[28:31], v[48:51], v[64:67], v[28:31]
    v_mfma_f32_16x16x32_f16 v[32:35], v[48:51], v[80:83], v[32:35]
    v_mfma_f32_16x16x32_f16 v[36:39], v[48:51], v[96:99], v[36:39]
    v_mfma_f32_16x16x32_f16 v[28:31], v[52:55], v[68:71], v[28:31]
    v_mfma_f32_16x16x32_f16 v[32:35], v[52:55], v[84:87], v[32:35]
    v_mfma_f32_16x16x32_f16 v[36:39], v[52:55], v[100:103], v[36:39]
    v_mov_b32 v40, 0
    v_mov_b32 v41, 0
    v_lshrrev_b32 v42, 2, v0
    v_mul_u32_u24 v42, 288, v42
    v_and_b32 v43, 3, v0
    v_lshl_add_u32 v42, v43, 3, v42
    v_add_u32_e64 v42, s79, v42
    v_cvt_pk_f16_f32 v44, v31, v30
    v_cvt_pk_f16_f32 v45, v29, v28
    v_cvt_pk_f16_f32 v46, v35, v34
    v_cvt_pk_f16_f32 v47, v33, v32
    v_cvt_pk_f16_f32 v48, v39, v38
    v_cvt_pk_f16_f32 v49, v37, v36
    v_mov_b32 v200, v1
    v_mov_b32 v201, v4
    v_add_u32 v202, 288, v4
    v_min_u32 v202, v202, v5
    v_add_u32 v203, 576, v4
    v_min_u32 v203, v203, v5
    v_add_u32 v204, 864, v4
    v_min_u32 v204, v204, v5
    v_add_u32 v205, 1152, v4
    v_min_u32 v205, v205, v5
    v_mov_b32 v206, v6
    v_add_u32 v207, 288, v6
    v_min_u32 v207, v207, v7
    v_add_u32 v208, 576, v6
    v_min_u32 v208, v208, v7
    v_add_u32 v209, 864, v6
    v_min_u32 v209, v209, v7
    v_add_u32 v210, 1152, v6
    v_min_u32 v210, v210, v7
    v_add_u32 v211, 1440, v6
    v_min_u32 v211, v211, v7
    v_add_u32 v212, 1728, v6
    v_min_u32 v212, v212, v7
    v_and_b32 v4, 15, v0
    v_lshrrev_b32 v5, 4, v0
    v_sub_u32 v6, 15, v4
    s_sub_u32 s77, s66, 1
    s_mul_i32 s77, s77, 4640
    s_add_u32 s77, s77, 104512
    s_sub_u32 s70, s77, s79
    v_and_b32 v2, 1, v6
    v_mul_lo_u32 v2, v2, s70
    v_lshrrev_b32 v6, 1, v6
    v_lshl_add_u32 v6, v6, 2, v2
    v_mul_u32_u24 v7, 288, v5
    v_add3_u32 v1, v6, v7, s79
    v_lshl_add_u32 v50, v0, 4, s79
    v_lshl_add_u32 v51, v0, 4, s77
    v_sub_u32 v6, v4, v5
    v_add_u32 v6, 4, v6
    v_mul_u32_u24 v6, 272, v6
    v_add_u32_e64 v3, s78, v6
    v_mov_b32 v5, 448
    s_mov_b32 s71, 0x200000
.tag_60:
    ds_read_b32 v4, v5
    s_waitcnt lgkmcnt(0)
    v_readfirstlane_b32 s70, v4
    s_nop 0
    s_cmp_lg_u32 s70, 0
    s_cbranch_scc1 .tage_61
    s_sleep 2
    s_sub_u32 s71, s71, 1
    s_cbranch_scc0 .tag_60
.tage_61:
    s_mov_b32 s67, s70
    v_and_b32 v6, 7, v0
    v_lshrrev_b32 v5, 3, v0
    v_mul_u32_u24 v5, 10240, v5
    v_lshl_add_u32 v6, v6, 4, v5
    s_lshr_b32 s70, s76, 6
    s_and_b32 s71, s76, 63
    s_sub_u32 s72, s70, 8
    s_lshl_b32 s72, s72, 2
    s_and_b32 s73, s76, 3
    s_add_u32 s72, s72, s73
    s_lshr_b32 s73, s71, 2
    s_add_u32 s73, s73, 64
    s_cmp_ge_u32 s76, 512
    s_cselect_b32 s74, s72, s70
    s_cselect_b32 s75, s73, s71
    s_mul_i32 s72, s74, 327680
    s_lshl_b32 s73, s75, 7
    s_add_u32 s72, s72, s73
    s_add_u32 s72, s72, 12582912
    v_mov_b32 v52, s82
    v_mov_b32 v53, s72
    v_mov_b32 v54, 1
    s_lshl_b32 s70, s66, 4
    v_mov_b32 v55, s70
    v_and_b32_e64 v61, 3, v0
    v_mul_u32_u24 v61, 80, v61
    s_mov_b32 s71, 0x200000
.k9_62:
    ds_read_b32 v60, v61 offset:100
    s_waitcnt lgkmcnt(0)
    v_cmp_eq_u32 vcc, 0, v60
    s_cbranch_vccz .k9e_63
    s_sleep 1
    s_sub_u32 s71, s71, 1
    s_cbranch_scc0 .k9_62
.k9e_63:
    s_setprio 0
    s_nop 0
    ds_write_b64 v42, v[40:41] offset:256
    ds_write_b64 v200, v[44:45] offset:0
    ds_write_b64 v201, v[46:47] offset:0
    ds_write_b64 v202, v[46:47] offset:0
    ds_write_b64 v203, v[46:47] offset:0
    ds_write_b64 v204, v[46:47] offset:0
    ds_write_b64 v205, v[46:47] offset:0
    ds_write_b64 v206, v[48:49] offset:0
    ds_write_b64 v207, v[48:49] offset:0
    ds_write_b64 v208, v[48:49] offset:0
    ds_write_b64 v209, v[48:49] offset:0
    ds_write_b64 v210, v[48:49] offset:0
    ds_write_b64 v211, v[48:49] offset:0
    ds_write_b64 v212, v[48:49] offset:0
    ds_read_b128 v[8:11], v50 offset:0
    ds_read_b32 v12, v50 offset:16
    ds_read_b128 v[16:19], v50 offset:1024
    ds_read_b32 v20, v50 offset:1040
    ds_read_b128 v[24:27], v50 offset:2048
    ds_read_b32 v28, v50 offset:2064
    ds_read_b128 v[32:35], v50 offset:3072
    ds_read_b32 v36, v50 offset:3088
    ds_read_b128 v[40:43], v50 offset:4096
    ds_read_b32 v44, v50 offset:4112
    s_waitcnt lgkmcnt(8)
    v_alignbyte_b32 v8, v9, v8, 2
    v_alignbyte_b32 v9, v10, v9, 2
    v_alignbyte_b32 v10, v11, v10, 2
    v_alignbyte_b32 v11, v12, v11, 2
    ds_write_b128 v51, v[8:11] offset:0
    s_waitcnt lgkmcnt(7)
    v_alignbyte_b32 v16, v17, v16, 2
    v_alignbyte_b32 v17, v18, v17, 2
    v_alignbyte_b32 v18, v19, v18, 2
    v_alignbyte_b32 v19, v20, v19, 2
    ds_write_b128 v51, v[16:19] offset:1024
    s_waitcnt lgkmcnt(6)
    v_alignbyte_b32 v24, v25, v24, 2
    v_alignbyte_b32 v25, v26, v25, 2
    v_alignbyte_b32 v26, v27, v26, 2
    v_alignbyte_b32 v27, v28, v27, 2
    ds_write_b128 v51, v[24:27] offset:2048
    s_waitcnt lgkmcnt(5)
    v_alignbyte_b32 v32, v33, v32, 2
    v_alignbyte_b32 v33, v34, v33, 2
    v_alignbyte_b32 v34, v35, v34, 2
    v_alignbyte_b32 v35, v36, v35, 2
    ds_write_b128 v51, v[32:35] offset:3072
    s_waitcnt lgkmcnt(4)
    v_alignbyte_b32 v40, v41, v40, 2
    v_alignbyte_b32 v41, v42, v41, 2
    v_alignbyte_b32 v42, v43, v42, 2
    v_alignbyte_b32 v43, v44, v43, 2
    s_mov_b32 exec_hi, 0
    ds_write_b128 v51, v[40:43] offset:4096
    s_mov_b32 exec_hi, -1
    s_nop 0
    ds_read2_b32 v[136:137], v1 offset0:0 offset1:1
    ds_read2_b32 v[138:139], v1 offset0:2 offset1:3
    ds_read2_b32 v[140:141], v1 offset0:4 offset1:5
    ds_read2_b32 v[142:143], v1 offset0:6 offset1:7
    ds_read2_b32 v[144:145], v1 offset0:8 offset1:9
    ds_read2_b32 v[146:147], v1 offset0:10 offset1:11
    ds_read2_b32 v[148:149], v1 offset0:12 offset1:13
    ds_read2_b32 v[150:151], v1 offset0:14 offset1:15
    ds_read2_b32 v[152:153], v1 offset0:16 offset1:17
    ds_read2_b32 v[154:155], v1 offset0:18 offset1:19
    ds_read2_b32 v[156:157], v1 offset0:20 offset1:21
    ds_read2_b32 v[158:159], v1 offset0:22 offset1:23
    ds_read2_b32 v[160:161], v1 offset0:24 offset1:25
    ds_read2_b32 v[162:163], v1 offset0:26 offset1:27
    ds_read2_b32 v[164:165], v1 offset0:28 offset1:29
    ds_read2_b32 v[166:167], v1 offset0:30 offset1:31
    ds_read2_b32 v[168:169], v1 offset0:32 offset1:33
    ds_read2_b32 v[170:171], v1 offset0:34 offset1:35
    ds_read2_b32 v[172:173], v1 offset0:36 offset1:37
    ds_read2_b32 v[174:175], v1 offset0:38 offset1:39
    ds_read2_b32 v[176:177], v1 offset0:40 offset1:41
    ds_read2_b32 v[178:179], v1 offset0:42 offset1:43
    ds_read2_b32 v[180:181], v1 offset0:44 offset1:45
    ds_read2_b32 v[182:183], v1 offset0:46 offset1:47
    ds_read2_b32 v[184:185], v1 offset0:48 offset1:49
    ds_read2_b32 v[186:187], v1 offset0:50 offset1:51
    ds_read2_b32 v[188:189], v1 offset0:52 offset1:53
    ds_read2_b32 v[190:191], v1 offset0:54 offset1:55
    ds_read2_b32 v[192:193], v1 offset0:56 offset1:57
    ds_read2_b32 v[194:195], v1 offset0:58 offset1:59
    ds_read2_b32 v[196:197], v1 offset0:60 offset1:61
    ds_read2_b32 v[198:199], v1 offset0:62 offset1:63
    v_add_u32 v1, 1152, v1
    v_mov_b32 v5, 452
    s_mov_b32 s71, 0x200000
.u_64:
    ds_read_b32 v4, v5
    s_waitcnt lgkmcnt(0)
    v_readfirstlane_b32 s70, v4
    s_nop 0
    s_cmp_lg_u32 s70, 0
    s_cbranch_scc1 .ue_65
    s_sleep 1
    s_sub_u32 s71, s71, 1
    s_cbranch_scc0 .u_64
.ue_65:
    ds_read_b128 v[8:11], v3 offset:3264
    ds_read_b128 v[12:15], v3 offset:3280
    ds_read_b128 v[16:19], v3 offset:3296
    ds_read_b128 v[20:23], v3 offset:3312
    ds_read_b128 v[24:27], v3 offset:3328
    ds_read_b128 v[28:31], v3 offset:3344
    s_lshl_b32 s73, s66, 4
    v_mov_b32 v5, s73
    s_mov_b32 s71, 0x200000
.cg_66:
    ds_read_b32 v4, v5
    s_waitcnt lgkmcnt(0)
    v_readfirstlane_b32 s70, v4
    s_nop 0
    s_cmp_ge_u32 s70, 12
    s_cbranch_scc1 .cge_67
    s_sleep 1
    s_sub_u32 s71, s71, 1
    s_cbranch_scc0 .cg_66
.cge_67:
    s_lshl_b32 s73, s66, 2
    v_mov_b32 v4, 1
    v_mov_b32 v5, s73
    s_setprio 0
    v_mfma_f32_16x16x32_f16 v[200:203], v[192:195], v[8:11], 0
    s_lshr_b32 s70, s67, 0
    s_lshl_b32 s70, s70, 13
    v_mov_b32 v240, s70
    v_mfma_f32_16x16x32_f16 v[200:203], v[196:199], v[12:15], v[200:203]
    s_lshr_b32 s70, s67, 2
    s_lshl_b32 s70, s70, 13
    v_mov_b32 v241, s70
    v_mfma_f32_16x16x32_f16 v[204:207], v[184:187], v[8:11], 0
    s_lshr_b32 s70, s67, 4
    s_lshl_b32 s70, s70, 13
    v_mov_b32 v242, s70
    v_mfma_f32_16x16x32_f16 v[204:207], v[188:191], v[12:15], v[204:207]
    s_lshr_b32 s70, s67, 6
    s_lshl_b32 s70, s70, 13
    v_mov_b32 v243, s70
    v_mfma_f32_16x16x32_f16 v[204:207], v[192:195], v[16:19], v[204:207]
    s_mov_b32 s83, 0x60006000
    v_mfma_f32_16x16x32_f16 v[204:207], v[196:199], v[20:23], v[204:207]
    ds_read2_b32 v[72:73], v1 offset0:0 offset1:1
    v_mfma_f32_16x16x32_f16 v[208:211], v[176:179], v[8:11], 0
    ds_read2_b32 v[74:75], v1 offset0:2 offset1:3
    v_mfma_f32_16x16x32_f16 v[208:211], v[180:183], v[12:15], v[208:211]
    ds_read2_b32 v[76:77], v1 offset0:4 offset1:5
    v_mfma_f32_16x16x32_f16 v[208:211], v[184:187], v[16:19], v[208:211]
    ds_read2_b32 v[78:79], v1 offset0:6 offset1:7
    v_mfma_f32_16x16x32_f16 v[208:211], v[188:191], v[20:23], v[208:211]
    ds_read2_b32 v[80:81], v1 offset0:8 offset1:9
    v_mfma_f32_16x16x32_f16 v[212:215], v[168:171], v[8:11], 0
    ds_read2_b32 v[82:83], v1 offset0:10 offset1:11
    v_mfma_f32_16x16x32_f16 v[212:215], v[172:175], v[12:15], v[212:215]
    ds_read2_b32 v[84:85], v1 offset0:12 offset1:13
    v_mfma_f32_16x16x32_f16 v[212:215], v[176:179], v[16:19], v[212:215]
    ds_read2_b32 v[86:87], v1 offset0:14 offset1:15
    v_mfma_f32_16x16x32_f16 v[212:215], v[180:183], v[20:23], v[212:215]
    ds_read2_b32 v[88:89], v1 offset0:16 offset1:17
    v_mfma_f32_16x16x32_f16 v[216:219], v[160:163], v[8:11], 0
    ds_read_b128 v[32:35], v3 offset:3360
    v_mfma_f32_16x16x32_f16 v[216:219], v[164:167], v[12:15], v[216:219]
    ds_read_b128 v[36:39], v3 offset:3376
    v_mfma_f32_16x16x32_f16 v[216:219], v[168:171], v[16:19], v[216:219]
    ds_read2_b32 v[90:91], v1 offset0:18 offset1:19
    v_mfma_f32_16x16x32_f16 v[216:219], v[172:175], v[20:23], v[216:219]
    ds_read2_b32 v[92:93], v1 offset0:20 offset1:21
    v_mfma_f32_16x16x32_f16 v[220:223], v[152:155], v[8:11], 0
    ds_read2_b32 v[94:95], v1 offset0:22 offset1:23
    v_mfma_f32_16x16x32_f16 v[220:223], v[156:159], v[12:15], v[220:223]
    ds_read2_b32 v[96:97], v1 offset0:24 offset1:25
    v_mfma_f32_16x16x32_f16 v[220:223], v[160:163], v[16:19], v[220:223]
    ds_read2_b32 v[98:99], v1 offset0:26 offset1:27
    v_mfma_f32_16x16x32_f16 v[220:223], v[164:167], v[20:23], v[220:223]
    ds_read2_b32 v[100:101], v1 offset0:28 offset1:29
    v_mfma_f32_16x16x32_f16 v[224:227], v[144:147], v[8:11], 0
    ds_read2_b32 v[102:103], v1 offset0:30 offset1:31
    v_mfma_f32_16x16x32_f16 v[224:227], v[148:151], v[12:15], v[224:227]
    ds_read2_b32 v[104:105], v1 offset0:32 offset1:33
    v_mfma_f32_16x16x32_f16 v[224:227], v[152:155], v[16:19], v[224:227]
    ds_read2_b32 v[106:107], v1 offset0:34 offset1:35
    v_mfma_f32_16x16x32_f16 v[224:227], v[156:159], v[20:23], v[224:227]
    ds_read2_b32 v[108:109], v1 offset0:36 offset1:37
    v_mfma_f32_16x16x32_f16 v[228:231], v[136:139], v[8:11], 0
    ds_read2_b32 v[110:111], v1 offset0:38 offset1:39
    v_mfma_f32_16x16x32_f16 v[228:231], v[140:143], v[12:15], v[228:231]
    ds_read2_b32 v[112:113], v1 offset0:40 offset1:41
    v_mfma_f32_16x16x32_f16 v[228:231], v[144:147], v[16:19], v[228:231]
    ds_read2_b32 v[114:115], v1 offset0:42 offset1:43
    v_mfma_f32_16x16x32_f16 v[228:231], v[148:151], v[20:23], v[228:231]
    ds_read2_b32 v[116:117], v1 offset0:44 offset1:45
    v_mfma_f32_16x16x32_f16 v[208:211], v[192:195], v[24:27], v[208:211]
    ds_read2_b32 v[118:119], v1 offset0:46 offset1:47
    v_mfma_f32_16x16x32_f16 v[208:211], v[196:199], v[28:31], v[208:211]
    ds_read2_b32 v[120:121], v1 offset0:48 offset1:49
    v_mfma_f32_16x16x32_f16 v[212:215], v[184:187], v[24:27], v[212:215]
    ds_read_b128 v[40:43], v3 offset:3392
    v_mfma_f32_16x16x32_f16 v[212:215], v[188:191], v[28:31], v[212:215]
    ds_read_b128 v[44:47], v3 offset:3408
    s_waitcnt lgkmcnt(15)
    v_mfma_f32_16x16x32_f16 v[212:215], v[192:195], v[32:35], v[212:215]
    ds_read2_b32 v[122:123], v1 offset0:50 offset1:51
    v_mfma_f32_16x16x32_f16 v[212:215], v[196:199], v[36:39], v[212:215]
    ds_read2_b32 v[124:125], v1 offset0:52 offset1:53
    v_mfma_f32_16x16x32_f16 v[216:219], v[176:179], v[24:27], v[216:219]
    ds_read_b128 v[48:51], v3 offset:3424
    v_mfma_f32_16x16x32_f16 v[216:219], v[180:183], v[28:31], v[216:219]
    ds_read_b128 v[52:55], v3 offset:3440
    v_mfma_f32_16x16x32_f16 v[216:219], v[184:187], v[32:35], v[216:219]
    ds_read2_b32 v[126:127], v1 offset0:54 offset1:55
    v_mfma_f32_16x16x32_f16 v[216:219], v[188:191], v[36:39], v[216:219]
    ds_read2_b32 v[128:129], v1 offset0:56 offset1:57
    v_mfma_f32_16x16x32_f16 v[220:223], v[168:171], v[24:27], v[220:223]
    ds_read2_b32 v[130:131], v1 offset0:58 offset1:59
    v_mfma_f32_16x16x32_f16 v[220:223], v[172:175], v[28:31], v[220:223]
    ds_read2_b32 v[132:133], v1 offset0:60 offset1:61
    v_mfma_f32_16x16x32_f16 v[220:223], v[176:179], v[32:35], v[220:223]
    ds_read2_b32 v[134:135], v1 offset0:62 offset1:63
    v_add_u32 v1, 1152, v1
    v_mfma_f32_16x16x32_f16 v[220:223], v[180:183], v[36:39], v[220:223]
    v_mfma_f32_16x16x32_f16 v[224:227], v[160:163], v[24:27], v[224:227]
    v_mfma_f32_16x16x32_f16 v[224:227], v[164:167], v[28:31], v[224:227]
    v_mfma_f32_16x16x32_f16 v[224:227], v[168:171], v[32:35], v[224:227]
    ds_read_b128 v[56:59], v3 offset:3456
    v_mfma_f32_16x16x32_f16 v[224:227], v[172:175], v[36:39], v[224:227]
    ds_read_b128 v[60:63], v3 offset:3472
    v_mfma_f32_16x16x32_f16 v[228:231], v[152:155], v[24:27], v[228:231]
    v_mfma_f32_16x16x32_f16 v[228:231], v[156:159], v[28:31], v[228:231]
    v_mfma_f32_16x16x32_f16 v[228:231], v[160:163], v[32:35], v[228:231]
    ds_read_b128 v[64:67], v3 offset:3488
    v_mfma_f32_16x16x32_f16 v[228:231], v[164:167], v[36:39], v[228:231]
    ds_read_b128 v[68:71], v3 offset:3504
    s_waitcnt lgkmcnt(14)
    v_mfma_f32_16x16x32_f16 v[216:219], v[192:195], v[40:43], v[216:219]
    ds_read_b128 v[8:11], v3 offset:2176
    s_waitcnt lgkmcnt(14)
    v_mfma_f32_16x16x32_f16 v[216:219], v[196:199], v[44:47], v[216:219]
    ds_read_b128 v[12:15], v3 offset:2192
    v_mfma_f32_16x16x32_f16 v[220:223], v[184:187], v[40:43], v[220:223]
    v_mfma_f32_16x16x32_f16 v[220:223], v[188:191], v[44:47], v[220:223]
    s_waitcnt lgkmcnt(12)
    v_mfma_f32_16x16x32_f16 v[220:223], v[192:195], v[48:51], v[220:223]
    ds_read_b128 v[16:19], v3 offset:2208
    s_waitcnt lgkmcnt(12)
    v_mfma_f32_16x16x32_f16 v[220:223], v[196:199], v[52:55], v[220:223]
    ds_read_b128 v[20:23], v3 offset:2224
    v_mfma_f32_16x16x32_f16 v[224:227], v[176:179], v[40:43], v[224:227]
    v_mfma_f32_16x16x32_f16 v[224:227], v[180:183], v[44:47], v[224:227]
    v_mfma_f32_16x16x32_f16 v[224:227], v[184:187], v[48:51], v[224:227]
    v_mfma_f32_16x16x32_f16 v[224:227], v[188:191], v[52:55], v[224:227]
    v_mfma_f32_16x16x32_f16 v[228:231], v[168:171], v[40:43], v[228:231]
    v_mfma_f32_16x16x32_f16 v[228:231], v[172:175], v[44:47], v[228:231]
    v_mfma_f32_16x16x32_f16 v[228:231], v[176:179], v[48:51], v[228:231]
    v_mfma_f32_16x16x32_f16 v[228:231], v[180:183], v[52:55], v[228:231]
    s_waitcnt lgkmcnt(7)
    v_mfma_f32_16x16x32_f16 v[224:227], v[192:195], v[56:59], v[224:227]
    s_waitcnt lgkmcnt(6)
    v_mfma_f32_16x16x32_f16 v[224:227], v[196:199], v[60:63], v[224:227]
    v_mfma_f32_16x16x32_f16 v[228:231], v[184:187], v[56:59], v[228:231]
    v_mfma_f32_16x16x32_f16 v[228:231], v[188:191], v[60:63], v[228:231]
    s_waitcnt lgkmcnt(5)
    v_mfma_f32_16x16x32_f16 v[228:231], v[192:195], v[64:67], v[228:231]
    s_waitcnt lgkmcnt(4)
    v_mfma_f32_16x16x32_f16 v[228:231], v[196:199], v[68:71], v[228:231]
    s_waitcnt lgkmcnt(3)
    v_mfma_f32_16x16x32_f16 v[200:203], v[128:131], v[8:11], v[200:203]
    ds_read2_b32 v[136:137], v1 offset0:0 offset1:1
    s_waitcnt lgkmcnt(3)
    v_mfma_f32_16x16x32_f16 v[200:203], v[132:135], v[12:15], v[200:203]
    ds_read2_b32 v[138:139], v1 offset0:2 offset1:3
    v_mfma_f32_16x16x32_f16 v[204:207], v[120:123], v[8:11], v[204:207]
    ds_read2_b32 v[140:141], v1 offset0:4 offset1:5
    v_mfma_f32_16x16x32_f16 v[204:207], v[124:127], v[12:15], v[204:207]
    ds_read2_b32 v[142:143], v1 offset0:6 offset1:7
    s_waitcnt lgkmcnt(5)
    v_mfma_f32_16x16x32_f16 v[204:207], v[128:131], v[16:19], v[204:207]
    ds_read2_b32 v[144:145], v1 offset0:8 offset1:9
    s_waitcnt lgkmcnt(5)
    v_mfma_f32_16x16x32_f16 v[204:207], v[132:135], v[20:23], v[204:207]
    ds_read2_b32 v[146:147], v1 offset0:10 offset1:11
    v_mfma_f32_16x16x32_f16 v[208:211], v[112:115], v[8:11], v[208:211]
    ds_read2_b32 v[148:149], v1 offset0:12 offset1:13
    v_mfma_f32_16x16x32_f16 v[208:211], v[116:119], v[12:15], v[208:211]
    ds_read2_b32 v[150:151], v1 offset0:14 offset1:15
    v_mfma_f32_16x16x32_f16 v[208:211], v[120:123], v[16:19], v[208:211]
    ds_read2_b32 v[152:153], v1 offset0:16 offset1:17
    v_mfma_f32_16x16x32_f16 v[208:211], v[124:127], v[20:23], v[208:211]
    ds_read2_b32 v[154:155], v1 offset0:18 offset1:19
    v_mfma_f32_16x16x32_f16 v[212:215], v[104:107], v[8:11], v[212:215]
    ds_read_b128 v[24:27], v3 offset:2240
    v_mfma_f32_16x16x32_f16 v[212:215], v[108:111], v[12:15], v[212:215]
    ds_read_b128 v[28:31], v3 offset:2256
    v_mfma_f32_16x16x32_f16 v[212:215], v[112:115], v[16:19], v[212:215]
    ds_read2_b32 v[156:157], v1 offset0:20 offset1:21
    v_mfma_f32_16x16x32_f16 v[212:215], v[116:119], v[20:23], v[212:215]
    ds_read2_b32 v[158:159], v1 offset0:22 offset1:23
    v_mfma_f32_16x16x32_f16 v[216:219], v[96:99], v[8:11], v[216:219]
    ds_read_b128 v[32:35], v3 offset:2272
    v_mfma_f32_16x16x32_f16 v[216:219], v[100:103], v[12:15], v[216:219]
    ds_read_b128 v[36:39], v3 offset:2288
    v_mfma_f32_16x16x32_f16 v[216:219], v[104:107], v[16:19], v[216:219]
    ds_read2_b32 v[160:161], v1 offset0:24 offset1:25
    v_mfma_f32_16x16x32_f16 v[216:219], v[108:111], v[20:23], v[216:219]
    ds_read2_b32 v[162:163], v1 offset0:26 offset1:27
    v_mfma_f32_16x16x32_f16 v[220:223], v[88:91], v[8:11], v[220:223]
    ds_read2_b32 v[164:165], v1 offset0:28 offset1:29
    v_mfma_f32_16x16x32_f16 v[220:223], v[92:95], v[12:15], v[220:223]
    ds_read2_b32 v[166:167], v1 offset0:30 offset1:31
    v_mfma_f32_16x16x32_f16 v[220:223], v[96:99], v[16:19], v[220:223]
    ds_read2_b32 v[168:169], v1 offset0:32 offset1:33
    v_mfma_f32_16x16x32_f16 v[220:223], v[100:103], v[20:23], v[220:223]
    ds_read2_b32 v[170:171], v1 offset0:34 offset1:35
    v_mfma_f32_16x16x32_f16 v[224:227], v[80:83], v[8:11], v[224:227]
    ds_read2_b32 v[172:173], v1 offset0:36 offset1:37
    v_mfma_f32_16x16x32_f16 v[224:227], v[84:87], v[12:15], v[224:227]
    ds_read2_b32 v[174:175], v1 offset0:38 offset1:39
    v_mfma_f32_16x16x32_f16 v[224:227], v[88:91], v[16:19], v[224:227]
    ds_read2_b32 v[176:177], v1 offset0:40 offset1:41
    v_mfma_f32_16x16x32_f16 v[224:227], v[92:95], v[20:23], v[224:227]
    ds_read2_b32 v[178:179], v1 offset0:42 offset1:43
    v_mfma_f32_16x16x32_f16 v[228:231], v[72:75], v[8:11], v[228:231]
    ds_read2_b32 v[180:181], v1 offset0:44 offset1:45
    v_mfma_f32_16x16x32_f16 v[228:231], v[76:79], v[12:15], v[228:231]
    ds_read2_b32 v[182:183], v1 offset0:46 offset1:47
    v_mfma_f32_16x16x32_f16 v[228:231], v[80:83], v[16:19], v[228:231]
    ds_read2_b32 v[184:185], v1 offset0:48 offset1:49
    v_mfma_f32_16x16x32_f16 v[228:231], v[84:87], v[20:23], v[228:231]
    ds_read2_b32 v[186:187], v1 offset0:50 offset1:51
    s_waitcnt lgkmcnt(15)
    v_mfma_f32_16x16x32_f16 v[208:211], v[128:131], v[24:27], v[208:211]
    ds_read2_b32 v[188:189], v1 offset0:52 offset1:53
    v_mfma_f32_16x16x32_f16 v[208:211], v[132:135], v[28:31], v[208:211]
    ds_read2_b32 v[190:191], v1 offset0:54 offset1:55
    v_mfma_f32_16x16x32_f16 v[212:215], v[120:123], v[24:27], v[212:215]
    ds_read_b128 v[40:43], v3 offset:2304
    v_mfma_f32_16x16x32_f16 v[212:215], v[124:127], v[28:31], v[212:215]
    ds_read_b128 v[44:47], v3 offset:2320
    v_mfma_f32_16x16x32_f16 v[212:215], v[128:131], v[32:35], v[212:215]
    ds_read2_b32 v[192:193], v1 offset0:56 offset1:57
    s_waitcnt lgkmcnt(15)
    v_mfma_f32_16x16x32_f16 v[212:215], v[132:135], v[36:39], v[212:215]
    ds_read2_b32 v[194:195], v1 offset0:58 offset1:59
    v_mfma_f32_16x16x32_f16 v[216:219], v[112:115], v[24:27], v[216:219]
    ds_read_b128 v[48:51], v3 offset:2336
    v_mfma_f32_16x16x32_f16 v[216:219], v[116:119], v[28:31], v[216:219]
    ds_read_b128 v[52:55], v3 offset:2352
    v_mfma_f32_16x16x32_f16 v[216:219], v[120:123], v[32:35], v[216:219]
    ds_read2_b32 v[196:197], v1 offset0:60 offset1:61
    v_mfma_f32_16x16x32_f16 v[216:219], v[124:127], v[36:39], v[216:219]
    ds_read2_b32 v[198:199], v1 offset0:62 offset1:63
    v_add_u32 v1, 1152, v1
    v_mfma_f32_16x16x32_f16 v[220:223], v[104:107], v[24:27], v[220:223]
    v_mfma_f32_16x16x32_f16 v[220:223], v[108:111], v[28:31], v[220:223]
    v_mfma_f32_16x16x32_f16 v[220:223], v[112:115], v[32:35], v[220:223]
    v_mfma_f32_16x16x32_f16 v[220:223], v[116:119], v[36:39], v[220:223]
    v_mfma_f32_16x16x32_f16 v[224:227], v[96:99], v[24:27], v[224:227]
    v_mfma_f32_16x16x32_f16 v[224:227], v[100:103], v[28:31], v[224:227]
    v_mfma_f32_16x16x32_f16 v[224:227], v[104:107], v[32:35], v[224:227]
    ds_read_b128 v[56:59], v3 offset:2368
    v_mfma_f32_16x16x32_f16 v[224:227], v[108:111], v[36:39], v[224:227]
    ds_read_b128 v[60:63], v3 offset:2384
    v_mfma_f32_16x16x32_f16 v[228:231], v[88:91], v[24:27], v[228:231]
    v_mfma_f32_16x16x32_f16 v[228:231], v[92:95], v[28:31], v[228:231]
    v_mfma_f32_16x16x32_f16 v[228:231], v[96:99], v[32:35], v[228:231]
    ds_read_b128 v[64:67], v3 offset:2400
    v_mfma_f32_16x16x32_f16 v[228:231], v[100:103], v[36:39], v[228:231]
    ds_read_b128 v[68:71], v3 offset:2416
    s_waitcnt lgkmcnt(11)
    v_mfma_f32_16x16x32_f16 v[216:219], v[128:131], v[40:43], v[216:219]
    ds_read_b128 v[8:11], v3 offset:1088
    s_waitcnt lgkmcnt(11)
    v_mfma_f32_16x16x32_f16 v[216:219], v[132:135], v[44:47], v[216:219]
    ds_read_b128 v[12:15], v3 offset:1104
    v_mfma_f32_16x16x32_f16 v[220:223], v[120:123], v[40:43], v[220:223]
    v_mfma_f32_16x16x32_f16 v[220:223], v[124:127], v[44:47], v[220:223]
    s_waitcnt lgkmcnt(9)
    v_mfma_f32_16x16x32_f16 v[220:223], v[128:131], v[48:51], v[220:223]
    ds_read_b128 v[16:19], v3 offset:1120
    s_waitcnt lgkmcnt(9)
    v_mfma_f32_16x16x32_f16 v[220:223], v[132:135], v[52:55], v[220:223]
    ds_read_b128 v[20:23], v3 offset:1136
    v_mfma_f32_16x16x32_f16 v[224:227], v[112:115], v[40:43], v[224:227]
    v_mfma_f32_16x16x32_f16 v[224:227], v[116:119], v[44:47], v[224:227]
    v_mfma_f32_16x16x32_f16 v[224:227], v[120:123], v[48:51], v[224:227]
    v_mfma_f32_16x16x32_f16 v[224:227], v[124:127], v[52:55], v[224:227]
    v_mfma_f32_16x16x32_f16 v[228:231], v[104:107], v[40:43], v[228:231]
    v_mfma_f32_16x16x32_f16 v[228:231], v[108:111], v[44:47], v[228:231]
    v_mfma_f32_16x16x32_f16 v[228:231], v[112:115], v[48:51], v[228:231]
    v_mfma_f32_16x16x32_f16 v[228:231], v[116:119], v[52:55], v[228:231]
    s_waitcnt lgkmcnt(7)
    v_mfma_f32_16x16x32_f16 v[224:227], v[128:131], v[56:59], v[224:227]
    s_waitcnt lgkmcnt(6)
    v_mfma_f32_16x16x32_f16 v[224:227], v[132:135], v[60:63], v[224:227]
    v_mfma_f32_16x16x32_f16 v[228:231], v[120:123], v[56:59], v[228:231]
    v_mfma_f32_16x16x32_f16 v[228:231], v[124:127], v[60:63], v[228:231]
    s_waitcnt lgkmcnt(5)
    v_mfma_f32_16x16x32_f16 v[228:231], v[128:131], v[64:67], v[228:231]
    s_waitcnt lgkmcnt(4)
    v_mfma_f32_16x16x32_f16 v[228:231], v[132:135], v[68:71], v[228:231]
    s_waitcnt lgkmcnt(3)
    v_mfma_f32_16x16x32_f16 v[200:203], v[192:195], v[8:11], v[200:203]
    ds_read2_b32 v[72:73], v1 offset0:0 offset1:1
    s_waitcnt lgkmcnt(3)
    v_mfma_f32_16x16x32_f16 v[200:203], v[196:199], v[12:15], v[200:203]
    ds_read2_b32 v[74:75], v1 offset0:2 offset1:3
    v_mfma_f32_16x16x32_f16 v[204:207], v[184:187], v[8:11], v[204:207]
    ds_read2_b32 v[76:77], v1 offset0:4 offset1:5
    v_mfma_f32_16x16x32_f16 v[204:207], v[188:191], v[12:15], v[204:207]
    ds_read2_b32 v[78:79], v1 offset0:6 offset1:7
    s_waitcnt lgkmcnt(5)
    v_mfma_f32_16x16x32_f16 v[204:207], v[192:195], v[16:19], v[204:207]
    ds_read2_b32 v[80:81], v1 offset0:8 offset1:9
    s_waitcnt lgkmcnt(5)
    v_mfma_f32_16x16x32_f16 v[204:207], v[196:199], v[20:23], v[204:207]
    ds_read2_b32 v[82:83], v1 offset0:10 offset1:11
    v_mfma_f32_16x16x32_f16 v[208:211], v[176:179], v[8:11], v[208:211]
    ds_read2_b32 v[84:85], v1 offset0:12 offset1:13
    v_mfma_f32_16x16x32_f16 v[208:211], v[180:183], v[12:15], v[208:211]
    ds_read2_b32 v[86:87], v1 offset0:14 offset1:15
    v_mfma_f32_16x16x32_f16 v[208:211], v[184:187], v[16:19], v[208:211]
    ds_read2_b32 v[88:89], v1 offset0:16 offset1:17
    v_mfma_f32_16x16x32_f16 v[208:211], v[188:191], v[20:23], v[208:211]
    ds_read2_b32 v[90:91], v1 offset0:18 offset1:19
    v_mfma_f32_16x16x32_f16 v[212:215], v[168:171], v[8:11], v[212:215]
    ds_read_b128 v[24:27], v3 offset:1152
    v_mfma_f32_16x16x32_f16 v[212:215], v[172:175], v[12:15], v[212:215]
    ds_read_b128 v[28:31], v3 offset:1168
    v_mfma_f32_16x16x32_f16 v[212:215], v[176:179], v[16:19], v[212:215]
    ds_read2_b32 v[92:93], v1 offset0:20 offset1:21
    v_mfma_f32_16x16x32_f16 v[212:215], v[180:183], v[20:23], v[212:215]
    ds_read2_b32 v[94:95], v1 offset0:22 offset1:23
    v_mfma_f32_16x16x32_f16 v[216:219], v[160:163], v[8:11], v[216:219]
    ds_read_b128 v[32:35], v3 offset:1184
    v_mfma_f32_16x16x32_f16 v[216:219], v[164:167], v[12:15], v[216:219]
    ds_read_b128 v[36:39], v3 offset:1200
    v_mfma_f32_16x16x32_f16 v[216:219], v[168:171], v[16:19], v[216:219]
    ds_read2_b32 v[96:97], v1 offset0:24 offset1:25
    v_mfma_f32_16x16x32_f16 v[216:219], v[172:175], v[20:23], v[216:219]
    ds_read2_b32 v[98:99], v1 offset0:26 offset1:27
    v_mfma_f32_16x16x32_f16 v[220:223], v[152:155], v[8:11], v[220:223]
    ds_read2_b32 v[100:101], v1 offset0:28 offset1:29
    v_mfma_f32_16x16x32_f16 v[220:223], v[156:159], v[12:15], v[220:223]
    ds_read2_b32 v[102:103], v1 offset0:30 offset1:31
    v_mfma_f32_16x16x32_f16 v[220:223], v[160:163], v[16:19], v[220:223]
    ds_read2_b32 v[104:105], v1 offset0:32 offset1:33
    v_mfma_f32_16x16x32_f16 v[220:223], v[164:167], v[20:23], v[220:223]
    ds_read2_b32 v[106:107], v1 offset0:34 offset1:35
    v_mfma_f32_16x16x32_f16 v[224:227], v[144:147], v[8:11], v[224:227]
    ds_read2_b32 v[108:109], v1 offset0:36 offset1:37
    v_mfma_f32_16x16x32_f16 v[224:227], v[148:151], v[12:15], v[224:227]
    ds_read2_b32 v[110:111], v1 offset0:38 offset1:39
    v_mfma_f32_16x16x32_f16 v[224:227], v[152:155], v[16:19], v[224:227]
    ds_read2_b32 v[112:113], v1 offset0:40 offset1:41
    v_mfma_f32_16x16x32_f16 v[224:227], v[156:159], v[20:23], v[224:227]
    ds_read2_b32 v[114:115], v1 offset0:42 offset1:43
    v_mfma_f32_16x16x32_f16 v[228:231], v[136:139], v[8:11], v[228:231]
    ds_read2_b32 v[116:117], v1 offset0:44 offset1:45
    v_mfma_f32_16x16x32_f16 v[228:231], v[140:143], v[12:15], v[228:231]
    ds_read2_b32 v[118:119], v1 offset0:46 offset1:47
    v_mfma_f32_16x16x32_f16 v[228:231], v[144:147], v[16:19], v[228:231]
    ds_read2_b32 v[120:121], v1 offset0:48 offset1:49
    v_mfma_f32_16x16x32_f16 v[228:231], v[148:151], v[20:23], v[228:231]
    ds_read2_b32 v[122:123], v1 offset0:50 offset1:51
    s_waitcnt lgkmcnt(15)
    v_mfma_f32_16x16x32_f16 v[208:211], v[192:195], v[24:27], v[208:211]
    ds_read2_b32 v[124:125], v1 offset0:52 offset1:53
    v_mfma_f32_16x16x32_f16 v[208:211], v[196:199], v[28:31], v[208:211]
    ds_read2_b32 v[126:127], v1 offset0:54 offset1:55
    v_mfma_f32_16x16x32_f16 v[212:215], v[184:187], v[24:27], v[212:215]
    ds_read_b128 v[40:43], v3 offset:1216
    v_mfma_f32_16x16x32_f16 v[212:215], v[188:191], v[28:31], v[212:215]
    ds_read_b128 v[44:47], v3 offset:1232
    v_mfma_f32_16x16x32_f16 v[212:215], v[192:195], v[32:35], v[212:215]
    ds_read2_b32 v[128:129], v1 offset0:56 offset1:57
    s_waitcnt lgkmcnt(15)
    v_mfma_f32_16x16x32_f16 v[212:215], v[196:199], v[36:39], v[212:215]
    ds_read2_b32 v[130:131], v1 offset0:58 offset1:59
    v_mfma_f32_16x16x32_f16 v[216:219], v[176:179], v[24:27], v[216:219]
    ds_read_b128 v[48:51], v3 offset:1248
    v_mfma_f32_16x16x32_f16 v[216:219], v[180:183], v[28:31], v[216:219]
    ds_read_b128 v[52:55], v3 offset:1264
    v_mfma_f32_16x16x32_f16 v[216:219], v[184:187], v[32:35], v[216:219]
    ds_read2_b32 v[132:133], v1 offset0:60 offset1:61
    v_mfma_f32_16x16x32_f16 v[216:219], v[188:191], v[36:39], v[216:219]
    ds_read2_b32 v[134:135], v1 offset0:62 offset1:63
    v_add_u32 v1, 1152, v1
    v_mfma_f32_16x16x32_f16 v[220:223], v[168:171], v[24:27], v[220:223]
    v_mfma_f32_16x16x32_f16 v[220:223], v[172:175], v[28:31], v[220:223]
    v_mfma_f32_16x16x32_f16 v[220:223], v[176:179], v[32:35], v[220:223]
    v_mfma_f32_16x16x32_f16 v[220:223], v[180:183], v[36:39], v[220:223]
    v_mfma_f32_16x16x32_f16 v[224:227], v[160:163], v[24:27], v[224:227]
    v_mfma_f32_16x16x32_f16 v[224:227], v[164:167], v[28:31], v[224:227]
    v_mfma_f32_16x16x32_f16 v[224:227], v[168:171], v[32:35], v[224:227]
    ds_read_b128 v[56:59], v3 offset:1280
    v_mfma_f32_16x16x32_f16 v[224:227], v[172:175], v[36:39], v[224:227]
    ds_read_b128 v[60:63], v3 offset:1296
    v_mfma_f32_16x16x32_f16 v[228:231], v[152:155], v[24:27], v[228:231]
    v_mfma_f32_16x16x32_f16 v[228:231], v[156:159], v[28:31], v[228:231]
    v_mfma_f32_16x16x32_f16 v[228:231], v[160:163], v[32:35], v[228:231]
    ds_read_b128 v[64:67], v3 offset:1312
    v_mfma_f32_16x16x32_f16 v[228:231], v[164:167], v[36:39], v[228:231]
    ds_read_b128 v[68:71], v3 offset:1328
    s_waitcnt lgkmcnt(11)
    v_mfma_f32_16x16x32_f16 v[216:219], v[192:195], v[40:43], v[216:219]
    ds_read_b128 v[8:11], v3 offset:0
    s_waitcnt lgkmcnt(11)
    v_mfma_f32_16x16x32_f16 v[216:219], v[196:199], v[44:47], v[216:219]
    ds_read_b128 v[12:15], v3 offset:16
    v_mfma_f32_16x16x32_f16 v[220:223], v[184:187], v[40:43], v[220:223]
    v_mfma_f32_16x16x32_f16 v[220:223], v[188:191], v[44:47], v[220:223]
    s_waitcnt lgkmcnt(9)
    v_mfma_f32_16x16x32_f16 v[220:223], v[192:195], v[48:51], v[220:223]
    ds_read_b128 v[16:19], v3 offset:32
    s_waitcnt lgkmcnt(9)
    v_mfma_f32_16x16x32_f16 v[220:223], v[196:199], v[52:55], v[220:223]
    ds_read_b128 v[20:23], v3 offset:48
    v_mfma_f32_16x16x32_f16 v[224:227], v[176:179], v[40:43], v[224:227]
    v_mfma_f32_16x16x32_f16 v[224:227], v[180:183], v[44:47], v[224:227]
    v_mfma_f32_16x16x32_f16 v[224:227], v[184:187], v[48:51], v[224:227]
    v_mfma_f32_16x16x32_f16 v[224:227], v[188:191], v[52:55], v[224:227]
    v_mfma_f32_16x16x32_f16 v[228:231], v[168:171], v[40:43], v[228:231]
    v_mfma_f32_16x16x32_f16 v[228:231], v[172:175], v[44:47], v[228:231]
    v_mfma_f32_16x16x32_f16 v[228:231], v[176:179], v[48:51], v[228:231]
    v_mfma_f32_16x16x32_f16 v[228:231], v[180:183], v[52:55], v[228:231]
    s_waitcnt lgkmcnt(7)
    v_mfma_f32_16x16x32_f16 v[224:227], v[192:195], v[56:59], v[224:227]
    s_waitcnt lgkmcnt(6)
    v_mfma_f32_16x16x32_f16 v[224:227], v[196:199], v[60:63], v[224:227]
    v_mfma_f32_16x16x32_f16 v[228:231], v[184:187], v[56:59], v[228:231]
    v_mfma_f32_16x16x32_f16 v[228:231], v[188:191], v[60:63], v[228:231]
    s_waitcnt lgkmcnt(5)
    v_mfma_f32_16x16x32_f16 v[228:231], v[192:195], v[64:67], v[228:231]
    s_waitcnt lgkmcnt(4)
    v_mfma_f32_16x16x32_f16 v[228:231], v[196:199], v[68:71], v[228:231]
    s_waitcnt lgkmcnt(3)
    v_mfma_f32_16x16x32_f16 v[200:203], v[128:131], v[8:11], v[200:203]
    s_waitcnt lgkmcnt(2)
    v_mfma_f32_16x16x32_f16 v[200:203], v[132:135], v[12:15], v[200:203]
    v_mfma_f32_16x16x32_f16 v[204:207], v[120:123], v[8:11], v[204:207]
    v_mfma_f32_16x16x32_f16 v[204:207], v[124:127], v[12:15], v[204:207]
    s_waitcnt lgkmcnt(1)
    v_mfma_f32_16x16x32_f16 v[204:207], v[128:131], v[16:19], v[204:207]
    s_waitcnt lgkmcnt(0)
    v_mfma_f32_16x16x32_f16 v[204:207], v[132:135], v[20:23], v[204:207]
    v_mfma_f32_16x16x32_f16 v[208:211], v[112:115], v[8:11], v[208:211]
    v_mfma_f32_16x16x32_f16 v[208:211], v[116:119], v[12:15], v[208:211]
    v_mfma_f32_16x16x32_f16 v[208:211], v[120:123], v[16:19], v[208:211]
    v_mfma_f32_16x16x32_f16 v[208:211], v[124:127], v[20:23], v[208:211]
    v_mul_f32 v200, s82, v200
    v_mul_f32 v201, s82, v201
    v_mfma_f32_16x16x32_f16 v[212:215], v[104:107], v[8:11], v[212:215]
    ds_read_b128 v[24:27], v3 offset:64
    v_mul_f32 v202, s82, v202
    v_mfma_f32_16x16x32_f16 v[212:215], v[108:111], v[12:15], v[212:215]
    ds_read_b128 v[28:31], v3 offset:80
    v_mul_f32_e64 v203, s82, v203
    v_mfma_f32_16x16x32_f16 v[212:215], v[112:115], v[16:19], v[212:215]
    v_cvt_pk_bf16_f32 v232, v200, v201
    v_cvt_pk_bf16_f32 v233, v202, v203
    v_mfma_f32_16x16x32_f16 v[212:215], v[116:119], v[20:23], v[212:215]
    v_bfi_b32 v232, s83, v240, v232
    v_bfi_b32 v233, s83, v241, v233
    v_mfma_f32_16x16x32_f16 v[216:219], v[96:99], v[8:11], v[216:219]
    ds_read_b128 v[32:35], v3 offset:96
    v_mul_f32 v204, s82, v204
    v_mfma_f32_16x16x32_f16 v[216:219], v[100:103], v[12:15], v[216:219]
    ds_read_b128 v[36:39], v3 offset:112
    v_mul_f32 v205, s82, v205
    v_mfma_f32_16x16x32_f16 v[216:219], v[104:107], v[16:19], v[216:219]
    v_mul_f32 v206, s82, v206
    v_mul_f32 v207, s82, v207
    v_mfma_f32_16x16x32_f16 v[216:219], v[108:111], v[20:23], v[216:219]
    v_cvt_pk_bf16_f32 v234, v204, v205
    v_cvt_pk_bf16_f32 v235, v206, v207
    v_mfma_f32_16x16x32_f16 v[220:223], v[88:91], v[8:11], v[220:223]
    v_bfi_b32 v234, s83, v242, v234
    v_bfi_b32 v235, s83, v243, v235
    v_mfma_f32_16x16x32_f16 v[220:223], v[92:95], v[12:15], v[220:223]
    buffer_store_dwordx4 v[232:235], v6, s[44:47], s72 offen sc1
    s_add_u32 s72, s72, 81920
    v_mfma_f32_16x16x32_f16 v[220:223], v[96:99], v[16:19], v[220:223]
    v_mfma_f32_16x16x32_f16 v[220:223], v[100:103], v[20:23], v[220:223]
    v_mfma_f32_16x16x32_f16 v[224:227], v[80:83], v[8:11], v[224:227]
    v_mfma_f32_16x16x32_f16 v[224:227], v[84:87], v[12:15], v[224:227]
    v_mfma_f32_16x16x32_f16 v[224:227], v[88:91], v[16:19], v[224:227]
    v_mfma_f32_16x16x32_f16 v[224:227], v[92:95], v[20:23], v[224:227]
    v_mfma_f32_16x16x32_f16 v[228:231], v[72:75], v[8:11], v[228:231]
    v_mfma_f32_16x16x32_f16 v[228:231], v[76:79], v[12:15], v[228:231]
    v_mfma_f32_16x16x32_f16 v[228:231], v[80:83], v[16:19], v[228:231]
    v_mfma_f32_16x16x32_f16 v[228:231], v[84:87], v[20:23], v[228:231]
    s_waitcnt lgkmcnt(3)
    v_mfma_f32_16x16x32_f16 v[208:211], v[128:131], v[24:27], v[208:211]
    s_waitcnt lgkmcnt(2)
    v_mfma_f32_16x16x32_f16 v[208:211], v[132:135], v[28:31], v[208:211]
    v_mfma_f32_16x16x32_f16 v[212:215], v[120:123], v[24:27], v[212:215]
    ds_read_b128 v[40:43], v3 offset:128
    v_mfma_f32_16x16x32_f16 v[212:215], v[124:127], v[28:31], v[212:215]
    ds_read_b128 v[44:47], v3 offset:144
    s_waitcnt lgkmcnt(3)
    v_mfma_f32_16x16x32_f16 v[212:215], v[128:131], v[32:35], v[212:215]
    s_waitcnt lgkmcnt(2)
    v_mfma_f32_16x16x32_f16 v[212:215], v[132:135], v[36:39], v[212:215]
    v_mfma_f32_16x16x32_f16 v[216:219], v[112:115], v[24:27], v[216:219]
    ds_read_b128 v[48:51], v3 offset:160
    v_mfma_f32_16x16x32_f16 v[216:219], v[116:119], v[28:31], v[216:219]
    ds_read_b128 v[52:55], v3 offset:176
    v_mfma_f32_16x16x32_f16 v[216:219], v[120:123], v[32:35], v[216:219]
    v_mfma_f32_16x16x32_f16 v[216:219], v[124:127], v[36:39], v[216:219]
    v_mul_f32 v208, s82, v208
    v_mul_f32 v209, s82, v209
    v_mfma_f32_16x16x32_f16 v[220:223], v[104:107], v[24:27], v[220:223]
    v_mul_f32 v210, s82, v210
    v_mul_f32 v211, s82, v211
    v_mfma_f32_16x16x32_f16 v[220:223], v[108:111], v[28:31], v[220:223]
    v_cvt_pk_bf16_f32 v236, v208, v209
    v_cvt_pk_bf16_f32 v237, v210, v211
    v_mfma_f32_16x16x32_f16 v[220:223], v[112:115], v[32:35], v[220:223]
    v_bfi_b32 v236, s83, v240, v236
    v_bfi_b32 v237, s83, v241, v237
    v_mfma_f32_16x16x32_f16 v[220:223], v[116:119], v[36:39], v[220:223]
    v_mul_f32 v212, s82, v212
    v_mul_f32 v213, s82, v213
    v_mfma_f32_16x16x32_f16 v[224:227], v[96:99], v[24:27], v[224:227]
    v_mul_f32 v214, s82, v214
    v_mul_f32 v215, s82, v215
    v_mfma_f32_16x16x32_f16 v[224:227], v[100:103], v[28:31], v[224:227]
    v_cvt_pk_bf16_f32 v238, v212, v213
    v_cvt_pk_bf16_f32 v239, v214, v215
    v_mfma_f32_16x16x32_f16 v[224:227], v[104:107], v[32:35], v[224:227]
    ds_read_b128 v[56:59], v3 offset:192
    v_bfi_b32 v238, s83, v242, v238
    v_mfma_f32_16x16x32_f16 v[224:227], v[108:111], v[36:39], v[224:227]
    ds_read_b128 v[60:63], v3 offset:208
    v_bfi_b32 v239, s83, v243, v239
    v_mfma_f32_16x16x32_f16 v[228:231], v[88:91], v[24:27], v[228:231]
    buffer_store_dwordx4 v[236:239], v6, s[44:47], s72 offen sc1
    s_add_u32 s72, s72, 81920
    v_mfma_f32_16x16x32_f16 v[228:231], v[92:95], v[28:31], v[228:231]
    v_mfma_f32_16x16x32_f16 v[228:231], v[96:99], v[32:35], v[228:231]
    ds_read_b128 v[64:67], v3 offset:224
    v_mfma_f32_16x16x32_f16 v[228:231], v[100:103], v[36:39], v[228:231]
    ds_read_b128 v[68:71], v3 offset:240
    s_waitcnt lgkmcnt(7)
    v_mfma_f32_16x16x32_f16 v[216:219], v[128:131], v[40:43], v[216:219]
    s_waitcnt lgkmcnt(6)
    v_mfma_f32_16x16x32_f16 v[216:219], v[132:135], v[44:47], v[216:219]
    v_mfma_f32_16x16x32_f16 v[220:223], v[120:123], v[40:43], v[220:223]
    v_mfma_f32_16x16x32_f16 v[220:223], v[124:127], v[44:47], v[220:223]
    s_waitcnt lgkmcnt(5)
    v_mfma_f32_16x16x32_f16 v[220:223], v[128:131], v[48:51], v[220:223]
    s_waitcnt lgkmcnt(4)
    v_mfma_f32_16x16x32_f16 v[220:223], v[132:135], v[52:55], v[220:223]
    v_mfma_f32_16x16x32_f16 v[224:227], v[112:115], v[40:43], v[224:227]
    v_mfma_f32_16x16x32_f16 v[224:227], v[116:119], v[44:47], v[224:227]
    v_mfma_f32_16x16x32_f16 v[224:227], v[120:123], v[48:51], v[224:227]
    v_mfma_f32_16x16x32_f16 v[224:227], v[124:127], v[52:55], v[224:227]
    v_mul_f32 v216, s82, v216
    v_mul_f32 v217, s82, v217
    v_mfma_f32_16x16x32_f16 v[228:231], v[104:107], v[40:43], v[228:231]
    v_mul_f32 v218, s82, v218
    v_mul_f32 v219, s82, v219
    v_mfma_f32_16x16x32_f16 v[228:231], v[108:111], v[44:47], v[228:231]
    v_cvt_pk_bf16_f32 v232, v216, v217
    v_cvt_pk_bf16_f32 v233, v218, v219
    v_mfma_f32_16x16x32_f16 v[228:231], v[112:115], v[48:51], v[228:231]
    v_bfi_b32 v232, s83, v240, v232
    v_bfi_b32 v233, s83, v241, v233
    v_mfma_f32_16x16x32_f16 v[228:231], v[116:119], v[52:55], v[228:231]
    v_mul_f32 v220, s82, v220
    v_mul_f32 v221, s82, v221
    s_waitcnt lgkmcnt(3)
    v_mfma_f32_16x16x32_f16 v[224:227], v[128:131], v[56:59], v[224:227]
    v_mul_f32 v222, s82, v222
    v_mul_f32 v223, s82, v223
    s_waitcnt lgkmcnt(2)
    v_mfma_f32_16x16x32_f16 v[224:227], v[132:135], v[60:63], v[224:227]
    v_cvt_pk_bf16_f32 v234, v220, v221
    v_cvt_pk_bf16_f32 v235, v222, v223
    v_mfma_f32_16x16x32_f16 v[228:231], v[120:123], v[56:59], v[228:231]
    v_bfi_b32 v234, s83, v242, v234
    v_bfi_b32 v235, s83, v243, v235
    v_mfma_f32_16x16x32_f16 v[228:231], v[124:127], v[60:63], v[228:231]
    buffer_store_dwordx4 v[232:235], v6, s[44:47], s72 offen sc1
    s_add_u32 s72, s72, 81920
    s_waitcnt lgkmcnt(1)
    v_mfma_f32_16x16x32_f16 v[228:231], v[128:131], v[64:67], v[228:231]
    s_waitcnt lgkmcnt(0)
    v_mfma_f32_16x16x32_f16 v[228:231], v[132:135], v[68:71], v[228:231]
    ds_write_b32 v5, v4 offset:460
    v_mul_f32 v224, s82, v224
    v_mul_f32 v225, s82, v225
    v_mul_f32 v226, s82, v226
    v_mul_f32 v227, s82, v227
    v_cvt_pk_bf16_f32 v236, v224, v225
    v_cvt_pk_bf16_f32 v237, v226, v227
    v_bfi_b32 v236, s83, v240, v236
    v_bfi_b32 v237, s83, v241, v237
    v_mul_f32 v228, s82, v228
    v_mul_f32 v229, s82, v229
    v_mul_f32 v230, s82, v230
    v_mul_f32 v231, s82, v231
    v_cvt_pk_bf16_f32 v238, v228, v229
    v_cvt_pk_bf16_f32 v239, v230, v231
    v_bfi_b32 v238, s83, v242, v238
    v_bfi_b32 v239, s83, v243, v239
    buffer_store_dwordx4 v[236:239], v6, s[44:47], s72 offen sc1
    s_endpgm
.Lend:
    s_endpgm
.rt_1:
    s_mov_b32 s71, 0x400000
.rt_1l:
    ds_read_b32 v19, v31 offset:64
    s_waitcnt lgkmcnt(0)
    v_cmp_eq_u32 vcc, 0, v19
    s_cbranch_vccz .rb_2
    s_sub_u32 s71, s71, 1
    s_cbranch_scc0 .rt_1l
    s_branch .rb_2
.rt_3:
    s_mov_b32 s71, 0x400000
.rt_3l:
    ds_read_b32 v19, v31 offset:68
    s_waitcnt lgkmcnt(0)
    v_cmp_eq_u32 vcc, 0, v19
    s_cbranch_vccz .rb_4
    s_sub_u32 s71, s71, 1
    s_cbranch_scc0 .rt_3l
    s_branch .rb_4
.rt_5:
    s_mov_b32 s71, 0x400000
.rt_5l:
    ds_read_b32 v19, v31 offset:72
    s_waitcnt lgkmcnt(0)
    v_cmp_eq_u32 vcc, 0, v19
    s_cbranch_vccz .rb_6
    s_sub_u32 s71, s71, 1
    s_cbranch_scc0 .rt_5l
    s_branch .rb_6
.rt_7:
    s_mov_b32 s71, 0x400000
.rt_7l:
    ds_read_b32 v19, v31 offset:76
    s_waitcnt lgkmcnt(0)
    v_cmp_eq_u32 vcc, 0, v19
    s_cbranch_vccz .rb_8
    s_sub_u32 s71, s71, 1
    s_cbranch_scc0 .rt_7l
    s_branch .rb_8
.rt_9:
    s_mov_b32 s71, 0x400000
.rt_9l:
    ds_read_b32 v19, v31 offset:80
    s_waitcnt lgkmcnt(0)
    v_cmp_eq_u32 vcc, 0, v19
    s_cbranch_vccz .rb_10
    s_sub_u32 s71, s71, 1
    s_cbranch_scc0 .rt_9l
    s_branch .rb_10
.rt_11:
    s_mov_b32 s71, 0x200000
.rt_11l:
    s_sleep 1
    ds_read_b32 v21, v20
    s_waitcnt lgkmcnt(0)
    v_cmp_eq_u32 vcc, 0, v21
    s_cbranch_vccz .rb_12
    s_sub_u32 s71, s71, 1
    s_cbranch_scc0 .rt_11l
    s_branch .rb_12
.rt_13:
    s_mov_b32 s71, 0x400000
.rt_13l:
    ds_read_b32 v19, v31 offset:84
    s_waitcnt lgkmcnt(0)
    v_cmp_eq_u32 vcc, 0, v19
    s_cbranch_vccz .rb_14
    s_sub_u32 s71, s71, 1
    s_cbranch_scc0 .rt_13l
    s_branch .rb_14
.rt_15:
    s_mov_b32 s71, 0x400000
.rt_15l:
    ds_read_b32 v19, v31 offset:88
    s_waitcnt lgkmcnt(0)
    v_cmp_eq_u32 vcc, 0, v19
    s_cbranch_vccz .rb_16
    s_sub_u32 s71, s71, 1
    s_cbranch_scc0 .rt_15l
    s_branch .rb_16
.rt_17:
    s_mov_b32 s71, 0x400000
.rt_17l:
    ds_read_b32 v19, v31 offset:92
    s_waitcnt lgkmcnt(0)
    v_cmp_eq_u32 vcc, 0, v19
    s_cbranch_vccz .rb_18
    s_sub_u32 s71, s71, 1
    s_cbranch_scc0 .rt_17l
    s_branch .rb_18
.rt_19:
    s_mov_b32 s71, 0x400000
.rt_19l:
    ds_read_b32 v19, v31 offset:96
    s_waitcnt lgkmcnt(0)
    v_cmp_eq_u32 vcc, 0, v19
    s_cbranch_vccz .rb_20
    s_sub_u32 s71, s71, 1
    s_cbranch_scc0 .rt_19l
    s_branch .rb_20
.rt_21:
    s_mov_b32 s71, 0x400000
.rt_21l:
    ds_read_b32 v19, v31 offset:100
    s_waitcnt lgkmcnt(0)
    v_cmp_eq_u32 vcc, 0, v19
    s_cbranch_vccz .rb_22
    s_sub_u32 s71, s71, 1
    s_cbranch_scc0 .rt_21l
    s_branch .rb_22
.rt_23:
    s_mov_b32 s71, 0x20000
.rt_23l:
    s_sleep 8
    buffer_load_dword v213, v209, s[44:47], s73 offen sc1
    s_waitcnt vmcnt(0)
    v_cmp_ne_u32 vcc, s67, v213
    s_cbranch_vccz .rb_24
    s_sub_u32 s71, s71, 1
    s_cbranch_scc0 .rt_23l
    s_branch .rb_24
.rt_25:
    s_mov_b32 s71, 0x20000
.rt_25l:
    s_sleep 4
    buffer_load_dwordx4 v[24:27], v208, s[44:47], s83 offen sc1
    s_waitcnt vmcnt(0)
    v_cmp_ne_u32 vcc, s67, v27
    s_cbranch_vccz .rb_26
    s_sub_u32 s71, s71, 1
    s_cbranch_scc0 .rt_25l
    s_branch .rb_26
.br_27:
    s_mov_b32 s71, 0x400000
.br_27l:
    ds_read_b32 v19, v9
    s_waitcnt lgkmcnt(0)
    v_cmp_gt_u32 vcc, 11, v19
    s_cbranch_vccz .bb_28
    s_sub_u32 s71, s71, 1
    s_cbranch_scc0 .br_27l
    s_branch .bb_28
.br_31:
    s_mov_b32 s71, 0x400000
.br_31l:
    ds_read_b32 v19, v9
    s_waitcnt lgkmcnt(0)
    v_cmp_gt_u32 vcc, 12, v19
    s_cbranch_vccz .bb_32
    s_sub_u32 s71, s71, 1
    s_cbranch_scc0 .br_31l
    s_branch .bb_32
.rt_33:
    s_mov_b32 s71, 0x40000
.rt_33l:
    s_sleep 1
    s_buffer_load_dwordx8 s[48:55], s[44:47], s74 glc
    s_waitcnt lgkmcnt(0)
    s_xor_b64 s[48:49], s[48:49], s[14:15]
    s_xor_b64 s[50:51], s[50:51], s[14:15]
    s_xor_b64 s[52:53], s[52:53], s[14:15]
    s_xor_b64 s[54:55], s[54:55], s[14:15]
    s_or_b64 s[48:49], s[48:49], s[50:51]
    s_or_b64 s[52:53], s[52:53], s[54:55]
    s_or_b64 vcc, s[48:49], s[52:53]
    s_cbranch_vccz .rb_34
    s_sub_u32 s71, s71, 1
    s_cbranch_scc0 .rt_33l
    s_branch .rb_34
.br_37:
    s_mov_b32 s71, 0x400000
.br_37l:
    ds_read_b32 v15, v9
    s_waitcnt lgkmcnt(0)
    v_cmp_gt_u32 vcc, 14, v15
    s_cbranch_vccz .bb_38
    s_sub_u32 s71, s71, 1
    s_cbranch_scc0 .br_37l
    s_branch .bb_38
.rt_39:
    s_mov_b32 s71, 0x200000
.rt_39l:
    s_sleep 1
    s_nop 0
    ds_read_b32 v12, v7
    ds_read_b64 v[156:157], v2 offset:0
    ds_read_b64 v[158:159], v2 offset:128
    ds_read_b64 v[168:169], v2 offset:256
    ds_read_b64 v[170:171], v2 offset:384
    ds_read_b64 v[212:213], v3 offset:8448
    s_waitcnt lgkmcnt(0)
    v_cmp_eq_u32 vcc, 0, v12
    s_cbranch_vccz .rb_40
    s_sub_u32 s71, s71, 1
    s_cbranch_scc0 .rt_39l
    s_branch .rb_40
.Lcode_end:
.section .rodata,"a"
.p2align 6
.amdhsa_kernel recurrent_scan__ssm_conv_s4__mixer_channel_mlp__prompt_kernel
  .amdhsa_next_free_vgpr 256
  .amdhsa_next_free_sgpr 102
  .amdhsa_accum_offset 256
  .amdhsa_group_segment_fixed_size 0
  .amdhsa_kernarg_size 136
  .amdhsa_user_sgpr_count 2
  .amdhsa_user_sgpr_kernarg_segment_ptr 1
  .amdhsa_system_sgpr_workgroup_id_x 1
  .amdhsa_float_denorm_mode_32 3
  .amdhsa_float_denorm_mode_16_64 3
.end_amdhsa_kernel
```
